```python
import torch

def _softmax(x, axis=-1):
    return torch.softmax(x, dim=axis)
def _gelu(x):
    return torch.nn.functional.gelu(x, approximate="tanh")
def _silu(x):
    return torch.nn.functional.silu(x)
def _sigmoid(x):
    return torch.sigmoid(x)
def _layernorm(x, axis=-1, eps=1e-5):
    m = x.mean(dim=axis, keepdim=True)
    v = x.var(dim=axis, keepdim=True, unbiased=False)
    return (x - m) / torch.sqrt(v + eps)
def _scatter_add(tgt, idx, src, axis=0):
    return tgt.clone().index_add_(axis, idx, src)
def _segment_sum(src, seg, n):
    out = torch.zeros((n,) + src.shape[1:], dtype=src.dtype)
    return out.index_add_(0, seg, src)
def _pad(x, pw):
    flat = tuple(v for pair in reversed(pw) for v in pair)
    return torch.nn.functional.pad(x, flat)

kernel_name = 'parallel_sum__softmax_full_mha__dense_activation_relu__prompt'

def setup_inputs():

    _w = (lambda a: (lambda t: t.to(torch.bfloat16) if t.is_floating_point() else t)(torch.as_tensor(a)))
    def _A_setup():
        B, S, D = 1, 2048, 448
        return {
            "x": _w((lambda *s: torch.randn(*s, dtype=torch.bfloat16) * 0.05)(B, S, D)),
            "wqkv": _w((lambda *s: torch.randn(*s, dtype=torch.bfloat16) * 0.2)(D, 3 * D)),
            "wo": _w((lambda *s: torch.randn(*s, dtype=torch.bfloat16) * 0.1)(D, D)),
        }
    _A_in = _A_setup()

    def _B_setup():
        B, S, D, Dff = 1, 2048, 448, 1792
        return {
            "x": _w((lambda *s: torch.randn(*s, dtype=torch.bfloat16) * 0.05)(B, S, D)),
            "w1": _w((lambda *s: torch.randn(*s, dtype=torch.bfloat16) * 0.2)(D, Dff)),
            "w2": _w((lambda *s: torch.randn(*s, dtype=torch.bfloat16) * 0.2)(Dff, D)),
        }
    _B_in = _B_setup()

    return {
        "A_x": _A_in["x"],
        "A_wqkv": _A_in["wqkv"],
        "A_wo": _A_in["wo"],
        "B_x": _B_in["x"],
        "B_w1": _B_in["w1"],
        "B_w2": _B_in["w2"],
    }

def reference(A_x, A_wqkv, A_wo, B_x, B_w1, B_w2):
    def _A_ref(x, wqkv, wo):
        B, S, D = x.shape
        H = 16; Dh = D // H
        qkv = (lambda x, *d: x.permute(*d))((x @ wqkv).reshape(B, S, 3, H, Dh), 2, 0, 3, 1, 4)
        q, k, v = qkv[0], qkv[1], qkv[2]
        scale = Dh ** -0.5
        scores = torch.einsum("bhqd,bhkd->bhqk", q, k) * scale
        p = _softmax(scores, axis=-1)
        o = torch.einsum("bhqk,bhkd->bhqd", p, v)
        return (lambda x, *d: x.permute(*d))(o, 0, 2, 1, 3).reshape(B, S, D) @ wo

    def _B_ref(x, w1, w2):
        h = torch.einsum("bsd,df->bsf", x, w1)
        zero = torch.zeros_like(h)
        h = torch.maximum(h, zero)
        return torch.einsum("bsf,fd->bsd", h, w2)

    x = A_x
    xn = _layernorm(x, axis=-1)
    return x + _A_ref(xn, A_wqkv, A_wo) + _B_ref(xn, B_w1, B_w2)
```

```asm
; @launch grid=(256,1,1) block=(512,1,1) lds=163840
.amdgcn_target "amdgcn-amd-amdhsa--gfx950"
.text
.globl parallel_sum__softmax_full_mha__dense_activation_relu__prompt_kernel
.p2align 8
.type parallel_sum__softmax_full_mha__dense_activation_relu__prompt_kernel,@function
parallel_sum__softmax_full_mha__dense_activation_relu__prompt_kernel:
    s_cmp_ge_u32 s2, 256
    s_cbranch_scc1 L_END
    s_load_dwordx4 s[40:43], s[0:1], 0
    s_load_dwordx2 s[44:45], s[0:1], 16
    s_load_dwordx4 s[48:51], s[0:1], 32
    s_load_dwordx4 s[52:55], s[0:1], 48
    s_load_dwordx2 s[46:47], s[0:1], 64
    s_getpc_b64 s[38:39]
L_PC:
    s_lshr_b32 s32, s2, 3
    v_lshlrev_b32 v16, 5, v0
    v_add_u32 v16, s32, v16
    v_cmp_gt_u32 vcc, (L_END-L_PC)/128, v16
    v_lshlrev_b32 v16, 7, v16
    s_and_saveexec_b64 s[36:37], vcc
    s_cbranch_execz L_NOCPF
    v_mov_b32 v17, s39
    v_add_co_u32 v16, vcc, s38, v16
    s_nop 1
    v_addc_co_u32 v17, vcc, 0, v17, vcc
    global_load_dword v254, v[16:17], off
L_NOCPF:
    s_mov_b64 exec, -1
    v_lshrrev_b32 v3, 6, v0
    v_and_b32 v1, 63, v0
    v_readfirstlane_b32 s28, v3
    v_lshlrev_b32 v2, 4, v1
    s_mov_b32 s36, 0
    s_mov_b32 s37, -1
    s_mov_b32 s35, 0xffff0000
    s_and_b32 s30, s2, 3
    s_lshl_b32 s30, s30, 2
    s_bfe_u32 s32, s2, 0x20003
    s_or_b32 s30, s30, s32
    s_lshr_b32 s29, s2, 5
    s_bfe_u32 s33, s2, 0x10002
    s_lshl_b32 s33, s33, 3
    s_or_b32 s29, s29, s33
    s_mul_i32 s31, s32, 2
    s_add_u32 s31, s31, s29
    s_mul_i32 s32, s31, 37
    s_lshr_b32 s32, s32, 8
    s_mul_i32 s32, s32, 7
    s_sub_u32 s31, s31, s32
    s_mov_b32 s3, s28
    s_lshl_b32 s32, s30, 2
    s_mov_b32 s38, 0x7e513042
    s_mov_b32 s39, 0x96dcbaf8
    s_lshr_b64 s[38:39], s[38:39], s32
    s_and_b32 s100, s38, 15
    s_mov_b32 s38, 0x76543210
    s_mov_b32 s39, 0xdbfcea98
    s_lshr_b64 s[38:39], s[38:39], s32
    s_and_b32 s101, s38, 15
    v_lshrrev_b32 v4, 5, v1
    v_bfe_u32 v5, v1, 4, 1
    v_bfe_u32 v6, v1, 2, 2
    v_and_b32 v7, 3, v1
    v_lshlrev_b32 v8, 6, v6
    v_lshl_add_u32 v8, v5, 5, v8
    v_lshl_add_u32 v8, v7, 3, v8
    s_cmp_ge_u32 s28, 4
    s_cbranch_scc0 L_A
    s_setprio 0
    s_and_b32 s28, s28, 3
    s_lshl_b32 s68, s29, 2
    s_add_u32 s68, s68, s28
    s_mul_i32 s68, s68, 28672
    v_lshrrev_b32 v17, 3, v1
    v_mul_u32_u24 v17, 896, v17
    v_lshrrev_b32 v16, 4, v1
    v_and_b32 v19, 7, v1
    v_xor_b32 v18, v16, v19
    v_lshl_add_u32 v24, v18, 4, v17
    v_xor_b32 v25, 64, v24
    v_add_u32 v26, 12288, v24
    v_add_u32 v27, 18432, v25
    v_add_u32 v25, 6144, v25
    v_lshl_add_u32 v17, v4, 2, v6
    v_mul_u32_u24 v17, 2688, v17
    v_mul_u32_u24 v18, 56, v5
    v_lshlrev_b32 v20, 4, v7
    v_min_u32 v20, 40, v20
    v_add3_u32 v28, v17, v18, v20
    v_add_u32 v29, 20480, v28
    s_and_b32 s32, s100, 14
    s_mul_i32 s32, s32, 56
    s_and_b32 s33, s100, 1
    s_add_u32 s33, s33, 1
    s_mul_i32 s33, s33, 896
    s_add_u32 s32, s32, s33
    s_mul_i32 s69, s28, 43008
    s_add_u32 s61, s69, s32
    s_waitcnt lgkmcnt(0)
    s_mov_b32 s72, s40
    s_mov_b32 s73, s41
    s_mov_b32 s74, 0x1c0000
    s_mov_b32 s75, 0x00020000
    s_mov_b32 s16, s42
    s_mov_b32 s17, s43
    s_mov_b32 s18, 0x126000
    s_mov_b32 s19, 0x00020000
    s_mov_b32 s34, s31
    s_lshl_b32 s32, s34, 7
    s_add_u32 s32, s32, s68
    s_lshl_b32 s33, s28, 12
    s_add_u32 m0, s33, 0
    s_nop 0
    buffer_load_dwordx4 v24, s[72:75], s32 offen offset:0 lds
    buffer_load_dwordx4 v25, s[72:75], s32 offen offset:1024 lds
    buffer_load_dwordx4 v26, s[72:75], s32 offen offset:2048 lds
    buffer_load_dwordx4 v27, s[72:75], s32 offen offset:3072 lds
    s_mul_i32 s32, s34, 172032
    s_add_u32 s32, s32, s61
    s_lshl_b32 s33, s28, 11
    s_add_u32 m0, s33, 16384
    s_nop 0
    buffer_load_dwordx4 v28, s[16:19], s32 offen offset:0 lds
    buffer_load_dwordx4 v29, s[16:19], s32 offen offset:1024 lds
    s_add_u32 s34, s34, 1
    s_cmp_eq_u32 s34, 7
    s_cselect_b32 s34, 0, s34
    s_lshl_b32 s32, s34, 7
    s_add_u32 s32, s32, s68
    s_lshl_b32 s33, s28, 12
    s_add_u32 m0, s33, 24576
    s_nop 0
    buffer_load_dwordx4 v24, s[72:75], s32 offen offset:0 lds
    buffer_load_dwordx4 v25, s[72:75], s32 offen offset:1024 lds
    buffer_load_dwordx4 v26, s[72:75], s32 offen offset:2048 lds
    buffer_load_dwordx4 v27, s[72:75], s32 offen offset:3072 lds
    s_mul_i32 s32, s34, 172032
    s_add_u32 s32, s32, s61
    s_lshl_b32 s33, s28, 11
    s_add_u32 m0, s33, 40960
    s_nop 0
    buffer_load_dwordx4 v28, s[16:19], s32 offen offset:0 lds
    buffer_load_dwordx4 v29, s[16:19], s32 offen offset:1024 lds
L_B2:
    s_and_b32 s4, s2, 3
    s_lshl_b32 s4, s4, 3
    s_bfe_u32 s32, s2, 0x30003
    s_add_u32 s4, s4, s32
    s_and_b32 s5, s2, 4
    s_lshr_b32 s32, s2, 6
    s_add_u32 s5, s5, s32
    s_bfe_u32 s33, s2, 0x10005
    s_bfe_u32 s6, s2, 0x10002
    s_cmp_eq_u32 s33, s6
    s_cselect_b32 s33, 3, 7
    s_cmp_eq_u32 s32, 3
    s_cselect_b32 s5, s33, s5
    v_mul_u32_u24 v17, 3584, v6
    v_lshl_add_u32 v17, v16, 6, v17
    v_lshl_add_u32 v30, v7, 4, v17
    v_add_u32 v31, 13312, v30
    v_add_u32 v32, 26624, v30
    v_add_u32 v33, 39936, v30
    s_mul_i32 s62, s28, 57344
    s_lshl_b32 s32, s101, 8
    s_add_u32 s62, s62, s32
    s_cmp_ge_u32 s101, 14
    s_cselect_b32 s62, 0x4000000, s62
    v_lshrrev_b32 v17, 2, v1
    v_mul_u32_u24 v17, 2688, v17
    v_add_u32 v34, v20, v17
    s_mul_i32 s32, s30, 56
    s_add_u32 s69, s69, s32
    v_lshl_add_u32 v16, v4, 2, v6
    v_mul_u32_u24 v17, 896, v16
    v_lshlrev_b32 v18, 4, v7
    v_lshl_add_u32 v19, v5, 6, v18
    s_lshr_b32 s32, s28, 1
    s_lshl_b32 s32, s32, 6
    v_xor_b32 v19, s32, v19
    v_add_u32 v11, v17, v19
    s_lshl_b32 s70, s28, 13
    s_add_u32 s70, s70, 81920
    s_mov_b32 s32, s70
    v_add_u32 v12, s32, v2
    v_lshl_add_u32 v13, v4, 9, v8
    v_add_u32 v10, s32, v13
    v_add_u32 v13, s70, v13
    v_mul_u32_u24 v17, 896, v4
    v_sub_u32 v8, v11, v17
    s_and_b32 s6, s5, 3
    s_mul_i32 s6, s6, 7
    s_and_b32 s32, s4, 7
    s_mul_i32 s32, s32, 7
    s_lshr_b32 s32, s32, 1
    s_add_u32 s6, s6, s32
    s_sub_u32 s32, s6, 28
    s_cmp_ge_u32 s6, 28
    s_cselect_b32 s6, s32, s6
    s_mov_b32 s7, s6
    s_mul_i32 s71, s28, 401408
    s_lshl_b32 s32, s5, 7
    s_add_u32 s71, s71, s32
    s_cmp_ge_u32 s5, 7
    s_cselect_b32 s71, 0x4000000, s71
    s_mov_b32 s20, s48
    s_mov_b32 s21, s49
    s_mov_b32 s22, 0x188000
    s_mov_b32 s23, 0x00020000
    s_mov_b32 s12, s50
    s_mov_b32 s13, s51
    s_mov_b32 s14, 0x188000
    s_mov_b32 s15, 0x00020000
    s_mov_b32 s8, s46
    s_mov_b32 s9, s47
    s_mov_b32 s10, 0xf00000
    s_mov_b32 s11, 0x00020000
    s_mov_b32 s24, s54
    s_mov_b32 s25, s55
    s_mov_b32 s26, 0x100
    s_mov_b32 s27, 0x00020000
    s_or_b32 s32, s2, s28
    s_cmp_lg_u32 s32, 0
    s_cbranch_scc1 L_BNW
    s_memrealtime s[58:59]
    v_mov_b32 v18, 0
    s_waitcnt lgkmcnt(0)
    s_or_b32 s58, s58, 1
    v_mov_b32 v16, s58
    v_mov_b32 v17, s59
    s_mov_b64 exec, 1
    buffer_store_dwordx2 v[16:17], v18, s[24:27], 0 offen sc1
    s_mov_b64 exec, -1
L_BNW:
    v_mov_b32 v40, 0
    v_mov_b32 v41, 0
    v_mov_b32 v42, 0
    v_mov_b32 v43, 0
    s_lshl_b32 s32, s28, 2
    s_add_u32 s32, s32, 153616
    v_mov_b32 v19, s32
    v_lshlrev_b32 v35, 2, v7
    v_add_u32 v35, 153600, v35
    s_waitcnt vmcnt(6)
    s_barrier
    s_add_u32 s34, s34, 1
    s_cmp_eq_u32 s34, 7
    s_cselect_b32 s34, 0, s34
    s_lshl_b32 s32, s34, 7
    s_add_u32 s32, s32, s68
    s_lshl_b32 s33, s28, 12
    s_add_u32 m0, s33, 49152
    s_nop 0
    buffer_load_dwordx4 v24, s[72:75], s32 offen offset:0 lds
    buffer_load_dwordx4 v25, s[72:75], s32 offen offset:1024 lds
    buffer_load_dwordx4 v26, s[72:75], s32 offen offset:2048 lds
    buffer_load_dwordx4 v27, s[72:75], s32 offen offset:3072 lds
    s_mul_i32 s32, s34, 172032
    s_add_u32 s32, s32, s61
    s_lshl_b32 s33, s28, 11
    s_add_u32 m0, s33, 65536
    s_nop 0
    buffer_load_dwordx4 v28, s[16:19], s32 offen offset:0 lds
    buffer_load_dwordx4 v29, s[16:19], s32 offen offset:1024 lds
    s_waitcnt vmcnt(6)
    s_barrier
    s_add_u32 s34, s34, 1
    s_cmp_eq_u32 s34, 7
    s_cselect_b32 s34, 0, s34
    s_lshl_b32 s32, s34, 7
    s_add_u32 s32, s32, s68
    s_lshl_b32 s33, s28, 12
    s_add_u32 m0, s33, 73728
    s_nop 0
    buffer_load_dwordx4 v24, s[72:75], s32 offen offset:0 lds
    buffer_load_dwordx4 v25, s[72:75], s32 offen offset:1024 lds
    buffer_load_dwordx4 v26, s[72:75], s32 offen offset:2048 lds
    buffer_load_dwordx4 v27, s[72:75], s32 offen offset:3072 lds
    s_mul_i32 s32, s34, 172032
    s_add_u32 s32, s32, s61
    s_lshl_b32 s33, s28, 11
    s_add_u32 m0, s33, 90112
    s_nop 0
    buffer_load_dwordx4 v28, s[16:19], s32 offen offset:0 lds
    buffer_load_dwordx4 v29, s[16:19], s32 offen offset:1024 lds
    s_waitcnt vmcnt(6)
    s_barrier
    s_add_u32 s34, s34, 1
    s_cmp_eq_u32 s34, 7
    s_cselect_b32 s34, 0, s34
    s_lshl_b32 s32, s34, 7
    s_add_u32 s32, s32, s68
    s_lshl_b32 s33, s28, 12
    s_add_u32 m0, s33, 98304
    s_nop 0
    buffer_load_dwordx4 v24, s[72:75], s32 offen offset:0 lds
    buffer_load_dwordx4 v25, s[72:75], s32 offen offset:1024 lds
    buffer_load_dwordx4 v26, s[72:75], s32 offen offset:2048 lds
    buffer_load_dwordx4 v27, s[72:75], s32 offen offset:3072 lds
    s_mul_i32 s32, s34, 172032
    s_add_u32 s32, s32, s61
    s_lshl_b32 s33, s28, 11
    s_add_u32 m0, s33, 114688
    s_nop 0
    buffer_load_dwordx4 v28, s[16:19], s32 offen offset:0 lds
    buffer_load_dwordx4 v29, s[16:19], s32 offen offset:1024 lds
    s_waitcnt vmcnt(6)
    s_barrier
    s_add_u32 s34, s34, 1
    s_cmp_eq_u32 s34, 7
    s_cselect_b32 s34, 0, s34
    s_lshl_b32 s32, s34, 7
    s_add_u32 s32, s32, s68
    s_lshl_b32 s33, s28, 12
    s_add_u32 m0, s33, 122880
    s_nop 0
    buffer_load_dwordx4 v24, s[72:75], s32 offen offset:0 lds
    buffer_load_dwordx4 v25, s[72:75], s32 offen offset:1024 lds
    buffer_load_dwordx4 v26, s[72:75], s32 offen offset:2048 lds
    buffer_load_dwordx4 v27, s[72:75], s32 offen offset:3072 lds
    s_mul_i32 s32, s34, 172032
    s_add_u32 s32, s32, s61
    s_lshl_b32 s33, s28, 11
    s_add_u32 m0, s33, 139264
    s_nop 0
    buffer_load_dwordx4 v28, s[16:19], s32 offen offset:0 lds
    buffer_load_dwordx4 v29, s[16:19], s32 offen offset:1024 lds
    s_add_u32 s34, s34, 1
    s_cmp_eq_u32 s34, 7
    s_cselect_b32 s34, 0, s34
    s_lshl_b32 s32, s34, 7
    s_add_u32 s32, s32, s68
    s_lshl_b32 s33, s28, 12
    s_add_u32 m0, s33, 0
    s_nop 0
    buffer_load_dwordx4 v24, s[72:75], s32 offen offset:0 lds
    buffer_load_dwordx4 v25, s[72:75], s32 offen offset:1024 lds
    buffer_load_dwordx4 v26, s[72:75], s32 offen offset:2048 lds
    buffer_load_dwordx4 v27, s[72:75], s32 offen offset:3072 lds
    s_mul_i32 s32, s34, 172032
    s_add_u32 s32, s32, s61
    s_lshl_b32 s33, s28, 11
    s_add_u32 m0, s33, 16384
    s_nop 0
    buffer_load_dwordx4 v28, s[16:19], s32 offen offset:0 lds
    buffer_load_dwordx4 v29, s[16:19], s32 offen offset:1024 lds
    buffer_load_dwordx2 v[36:37], v40, s[24:27], 0 offen sc1
    s_waitcnt vmcnt(13)
    s_barrier
    s_mov_b32 s34, s31
    s_mul_i32 s32, s34, 229376
    s_add_u32 s32, s32, s62
    s_mul_i32 s33, s28, 5120
    s_add_u32 m0, s33, 24576
    s_nop 0
    buffer_load_dwordx4 v30, s[20:23], s32 offen offset:0 lds
    buffer_load_dwordx4 v31, s[20:23], s32 offen offset:1024 lds
    buffer_load_dwordx4 v32, s[20:23], s32 offen offset:2048 lds
    buffer_load_dwordx4 v33, s[20:23], s32 offen offset:3072 lds
    s_mul_i32 s32, s34, 172032
    s_add_u32 s32, s32, s69
    s_add_u32 m0, s33, 28672
    s_nop 0
    buffer_load_dwordx4 v34, s[16:19], s32 offen lds
    s_waitcnt vmcnt(12)
    s_barrier
    s_add_u32 s34, s34, 1
    s_cmp_eq_u32 s34, 7
    s_cselect_b32 s34, 0, s34
    s_mul_i32 s32, s34, 229376
    s_add_u32 s32, s32, s62
    s_mul_i32 s33, s28, 5120
    s_add_u32 m0, s33, 49152
    s_nop 0
    buffer_load_dwordx4 v30, s[20:23], s32 offen offset:0 lds
    buffer_load_dwordx4 v31, s[20:23], s32 offen offset:1024 lds
    buffer_load_dwordx4 v32, s[20:23], s32 offen offset:2048 lds
    buffer_load_dwordx4 v33, s[20:23], s32 offen offset:3072 lds
    s_mul_i32 s32, s34, 172032
    s_add_u32 s32, s32, s69
    s_add_u32 m0, s33, 53248
    s_nop 0
    buffer_load_dwordx4 v34, s[16:19], s32 offen lds
    s_waitcnt vmcnt(11)
    s_barrier
    s_add_u32 s34, s34, 1
    s_cmp_eq_u32 s34, 7
    s_cselect_b32 s34, 0, s34
    s_mul_i32 s32, s34, 229376
    s_add_u32 s32, s32, s62
    s_mul_i32 s33, s28, 5120
    s_add_u32 m0, s33, 73728
    s_nop 0
    buffer_load_dwordx4 v30, s[20:23], s32 offen offset:0 lds
    buffer_load_dwordx4 v31, s[20:23], s32 offen offset:1024 lds
    buffer_load_dwordx4 v32, s[20:23], s32 offen offset:2048 lds
    buffer_load_dwordx4 v33, s[20:23], s32 offen offset:3072 lds
    s_mul_i32 s32, s34, 172032
    s_add_u32 s32, s32, s69
    s_add_u32 m0, s33, 77824
    s_nop 0
    buffer_load_dwordx4 v34, s[16:19], s32 offen lds
    s_add_u32 s34, s34, 1
    s_cmp_eq_u32 s34, 7
    s_cselect_b32 s34, 0, s34
    s_mul_i32 s32, s34, 229376
    s_add_u32 s32, s32, s62
    s_mul_i32 s33, s28, 5120
    s_add_u32 m0, s33, 98304
    s_nop 0
    buffer_load_dwordx4 v30, s[20:23], s32 offen offset:0 lds
    buffer_load_dwordx4 v31, s[20:23], s32 offen offset:1024 lds
    buffer_load_dwordx4 v32, s[20:23], s32 offen offset:2048 lds
    buffer_load_dwordx4 v33, s[20:23], s32 offen offset:3072 lds
    s_mul_i32 s32, s34, 172032
    s_add_u32 s32, s32, s69
    s_add_u32 m0, s33, 102400
    s_nop 0
    buffer_load_dwordx4 v34, s[16:19], s32 offen lds
    s_add_u32 s34, s34, 1
    s_cmp_eq_u32 s34, 7
    s_cselect_b32 s34, 0, s34
    s_mul_i32 s32, s34, 229376
    s_add_u32 s32, s32, s62
    s_mul_i32 s33, s28, 5120
    s_add_u32 m0, s33, 122880
    s_nop 0
    buffer_load_dwordx4 v30, s[20:23], s32 offen offset:0 lds
    buffer_load_dwordx4 v31, s[20:23], s32 offen offset:1024 lds
    buffer_load_dwordx4 v32, s[20:23], s32 offen offset:2048 lds
    buffer_load_dwordx4 v33, s[20:23], s32 offen offset:3072 lds
    s_mul_i32 s32, s34, 172032
    s_add_u32 s32, s32, s69
    s_add_u32 m0, s33, 126976
    s_nop 0
    buffer_load_dwordx4 v34, s[16:19], s32 offen lds
    s_lshl_b32 s64, s29, 2
    s_add_u32 s64, s64, s28
    s_and_b32 s65, s100, 14
    s_lshl_b32 s65, s65, 6
    s_add_u32 s65, s65, s64
    s_lshl_b32 s65, s65, 1
    s_and_b32 s32, s100, 1
    s_add_u32 s65, s65, s32
    s_lshl_b32 s65, s65, 11
    s_add_u32 s65, s65, 0x200000
    s_add_u32 s66, s65, 262144
    s_lshr_b32 s67, s64, 1
    s_mul_i32 s67, s67, 72
    s_add_u32 s67, s67, s30
    s_add_u32 s67, s67, 56
    s_lshl_b32 s67, s67, 2
    s_and_b32 s32, s64, 1
    s_add_u32 s67, s67, s32
    s_lshl_b32 s67, s67, 10
    s_add_u32 s67, s67, 0x600000
    s_lshl_b32 s32, s28, 12
    v_add_u32 v16, s32, v2
    v_and_b32 v17, 1, v7
    v_lshl_add_u32 v18, v4, 2, v6
    v_lshl_add_u32 v17, v17, 5, v18
    v_lshlrev_b32 v17, 4, v17
    v_lshl_add_u32 v17, v5, 10, v17
    v_lshrrev_b32 v18, 1, v7
    v_lshl_add_u32 v17, v18, 3, v17
    v_add_u32 v17, s32, v17
    v_and_b32 v20, 31, v1
    v_mov_b32 v18, v20
    v_cmp_le_u32 vcc, 11, v20
    s_nop 1
    v_addc_co_u32 v18, vcc, 0, v18, vcc
    v_cmp_le_u32 vcc, 14, v20
    s_nop 1
    v_addc_co_u32 v18, vcc, 0, v18, vcc
    v_cmp_le_u32 vcc, 25, v20
    s_nop 1
    v_addc_co_u32 v18, vcc, 0, v18, vcc
    v_and_b32 v22, 1, v20
    v_lshlrev_b32 v22, 2, v22
    v_bfe_u32 v23, v20, 1, 1
    v_lshl_add_u32 v22, v23, 4, v22
    v_add_u32 v22, 11, v22
    s_mov_b32 s38, 0xf0000000
    s_mov_b32 s39, 0xf0000000
    v_cndmask_b32 v18, v18, v22, s[38:39]
    s_bitcmp1_b32 s100, 0
    s_cselect_b32 s38, -1, 0
    s_mov_b32 s39, s38
    v_cndmask_b32 v18, v20, v18, s[38:39]
    v_lshl_add_u32 v18, v4, 5, v18
    v_lshlrev_b32 v18, 4, v18
    s_waitcnt vmcnt(10)
    s_mov_b32 s56, 131072
L_BN:
    v_readfirstlane_b32 s58, v36
    v_readfirstlane_b32 s59, v37
    s_cmp_lg_u32 s58, 0
    s_cbranch_scc1 L_BNX
    buffer_load_dwordx2 v[36:37], v40, s[24:27], 0 offen sc1
    s_sub_u32 s56, s56, 1
    s_cbranch_scc1 L_BNX
    s_waitcnt vmcnt(0)
    s_branch L_BN
L_BNX:
    v_mov_b32 v38, v36
    v_mov_b32 v39, v37
    s_barrier
    s_bitcmp1_b32 s100, 0
    s_cbranch_scc1 L_VT
    ds_read_b128 v[44:47], v16 offset:0
    ds_read_b128 v[48:51], v16 offset:1024
    ds_read_b128 v[52:55], v16 offset:2048
    ds_read_b128 v[56:59], v16 offset:3072
    s_branch L_VJ
L_VT:
    ds_read_b64_tr_b16 v[44:45], v17 offset:0
    ds_read_b64_tr_b16 v[46:47], v17 offset:128
    ds_read_b64_tr_b16 v[48:49], v17 offset:256
    ds_read_b64_tr_b16 v[50:51], v17 offset:384
    ds_read_b64_tr_b16 v[52:53], v17 offset:2048
    ds_read_b64_tr_b16 v[54:55], v17 offset:2176
    ds_read_b64_tr_b16 v[56:57], v17 offset:2304
    ds_read_b64_tr_b16 v[58:59], v17 offset:2432
L_VJ:
    s_waitcnt lgkmcnt(3)
    buffer_store_dwordx4 v[44:47], v18, s[8:11], s65 offen offset:0 sc1
    s_waitcnt lgkmcnt(2)
    buffer_store_dwordx4 v[48:51], v18, s[8:11], s65 offen offset:1024 sc1
    s_waitcnt lgkmcnt(1)
    buffer_store_dwordx4 v[52:55], v18, s[8:11], s66 offen offset:0 sc1
    s_waitcnt lgkmcnt(0)
    buffer_store_dwordx4 v[56:59], v18, s[8:11], s66 offen offset:1024 sc1
    s_waitcnt vmcnt(4)
    s_setprio 3
    v_mov_b32 v21, 12
    ds_write_b32 v19, v21 offset:48
    s_setprio 0
    s_lshl_b32 s65, s100, 4
    s_add_u32 s65, s65, s29
    s_lshl_b32 s65, s65, 7
    s_lshl_b32 s66, s29, 4
    s_add_u32 s66, s66, s30
    s_lshl_b32 s66, s66, 7
    s_add_u32 s60, s66, 0x10000
    s_lshl_b32 s66, s29, 4
    s_add_u32 s66, s66, s101
    s_lshl_b32 s66, s66, 7
    s_add_u32 s66, s66, 0x8000
    s_waitcnt vmcnt(0)
    s_setprio 3
    v_mov_b32 v22, 153696
    v_mov_b32 v23, 1
    s_mov_b64 exec, 1
    ds_add_rtn_u32 v23, v22, v23
    s_mov_b64 exec, -1
    s_waitcnt lgkmcnt(0)
    v_readfirstlane_b32 s32, v23
    s_cmp_lg_u32 s32, 3
    s_cbranch_scc1 L_FS0
    s_mov_b64 exec, 0xff
    buffer_store_dwordx4 v[36:39], v2, s[8:11], s65 offen sc1
    s_mov_b64 exec, -1
L_FS0:
    s_setprio 0
    s_setprio 3
    s_mov_b32 s56, 1048576
L_PG0:
    ds_read_b32 v21, v35 offset:64
    s_sub_u32 s56, s56, 1
    s_cbranch_scc1 L_PGX0
    s_waitcnt lgkmcnt(0)
    v_cmp_gt_u32 vcc, 12, v21
    s_cbranch_vccz L_PGX0
    s_sleep 2
    s_branch L_PG0
L_PGX0:
    s_setprio 0
    s_add_u32 s34, s34, 1
    s_cmp_eq_u32 s34, 7
    s_cselect_b32 s34, 0, s34
    s_mul_i32 s32, s34, 229376
    s_add_u32 s32, s32, s62
    s_mul_i32 s33, s28, 5120
    s_add_u32 m0, s33, 0
    s_nop 0
    buffer_load_dwordx4 v30, s[20:23], s32 offen offset:0 lds
    buffer_load_dwordx4 v31, s[20:23], s32 offen offset:1024 lds
    buffer_load_dwordx4 v32, s[20:23], s32 offen offset:2048 lds
    buffer_load_dwordx4 v33, s[20:23], s32 offen offset:3072 lds
    s_mul_i32 s32, s34, 172032
    s_add_u32 s32, s32, s69
    s_add_u32 m0, s33, 4096
    s_nop 0
    buffer_load_dwordx4 v34, s[16:19], s32 offen lds
    s_setprio 3
    s_mov_b32 s56, 1048576
L_PG1:
    ds_read_b32 v21, v35 offset:80
    s_sub_u32 s56, s56, 1
    s_cbranch_scc1 L_PGX1
    s_waitcnt lgkmcnt(0)
    v_cmp_gt_u32 vcc, 8, v21
    s_cbranch_vccz L_PGX1
    s_sleep 2
    s_branch L_PG1
L_PGX1:
    s_setprio 0
    s_add_u32 s34, s34, 1
    s_cmp_eq_u32 s34, 7
    s_cselect_b32 s34, 0, s34
    s_mul_i32 s32, s34, 229376
    s_add_u32 s32, s32, s62
    s_mul_i32 s33, s28, 5120
    s_add_u32 m0, s33, 24576
    s_nop 0
    buffer_load_dwordx4 v30, s[20:23], s32 offen offset:0 lds
    buffer_load_dwordx4 v31, s[20:23], s32 offen offset:1024 lds
    buffer_load_dwordx4 v32, s[20:23], s32 offen offset:2048 lds
    buffer_load_dwordx4 v33, s[20:23], s32 offen offset:3072 lds
    s_mul_i32 s32, s34, 172032
    s_add_u32 s32, s32, s69
    s_add_u32 m0, s33, 28672
    s_nop 0
    buffer_load_dwordx4 v34, s[16:19], s32 offen lds
    buffer_store_dwordx4 v[40:43], v2, s[8:11], s67 offen offset:0 sc1
    buffer_store_dwordx4 v[40:43], v2, s[8:11], s67 offen offset:2048 sc1
    v_lshlrev_b32 v16, 7, v7
    v_bfe_u32 v17, v1, 2, 1
    v_lshl_add_u32 v16, v17, 11, v16
    s_and_b32 s65, s30, 14
    s_lshl_b32 s65, s65, 2
    s_add_u32 s65, s65, s28
    s_lshl_b32 s65, s65, 9
    s_lshl_b32 s67, s30, 2
    s_add_u32 s67, s67, s28
    s_lshl_b32 s67, s67, 16
    s_add_u32 s67, s67, 0x200000
    s_lshl_b32 s32, s28, 13
    v_add_u32 v17, s32, v2
    s_mul_i32 s32, s28, 24576
    s_add_u32 s32, s32, 20480
    s_lshl_b32 s33, s28, 12
    s_add_u32 s33, s33, 135168
    s_cmp_ge_u32 s28, 2
    s_cselect_b32 s32, s33, s32
    v_add_u32 v18, s32, v2
    v_add_u32 v20, 81920, v17
    s_waitcnt vmcnt(2)
    s_setprio 3
    v_mov_b32 v21, 14
    ds_write_b32 v19, v21 offset:48
    s_setprio 0
    s_setprio 3
    s_mov_b32 s56, 131072
L_BP0:
    buffer_load_dwordx2 v[22:23], v16, s[8:11], s65 offen sc1
    s_sub_u32 s56, s56, 1
    s_cbranch_scc1 L_BPX0
    s_waitcnt vmcnt(0)
    v_cmp_ne_u64 vcc, s[58:59], v[22:23]
    s_cbranch_vccz L_BPX0
    s_branch L_BP0
L_BPX0:
    s_setprio 0
    s_add_u32 s32, s29, 0
    s_and_b32 s32, s32, 15
    s_lshl_b32 s32, s32, 12
    s_add_u32 s32, s32, s67
    buffer_load_dwordx4 v[44:47], v2, s[8:11], s32 offen offset:0 sc1
    buffer_load_dwordx4 v[48:51], v2, s[8:11], s32 offen offset:1024 sc1
    buffer_load_dwordx4 v[52:55], v2, s[8:11], s32 offen offset:2048 sc1
    buffer_load_dwordx4 v[56:59], v2, s[8:11], s32 offen offset:3072 sc1
    s_add_u32 s32, s29, 1
    s_and_b32 s32, s32, 15
    s_lshl_b32 s32, s32, 12
    s_add_u32 s32, s32, s67
    buffer_load_dwordx4 v[60:63], v2, s[8:11], s32 offen offset:0 sc1
    buffer_load_dwordx4 v[64:67], v2, s[8:11], s32 offen offset:1024 sc1
    buffer_load_dwordx4 v[68:71], v2, s[8:11], s32 offen offset:2048 sc1
    buffer_load_dwordx4 v[72:75], v2, s[8:11], s32 offen offset:3072 sc1
    s_add_u32 s32, s29, 2
    s_and_b32 s32, s32, 15
    s_lshl_b32 s32, s32, 12
    s_add_u32 s32, s32, s67
    buffer_load_dwordx4 v[76:79], v2, s[8:11], s32 offen offset:0 sc1
    buffer_load_dwordx4 v[24:27], v2, s[8:11], s32 offen offset:1024 sc1
    buffer_load_dwordx4 v[28:31], v2, s[8:11], s32 offen offset:2048 sc1
    buffer_load_dwordx4 v[40:43], v2, s[8:11], s32 offen offset:3072 sc1
    s_mul_i32 s32, s7, 14336
    s_add_u32 s32, s32, s71
    s_add_u32 s33, s32, 7168
    s_add_u32 s7, s7, 1
    s_cmp_eq_u32 s7, 28
    s_cselect_b32 s7, 0, s7
    buffer_load_dwordx4 v[80:83], v11, s[12:15], s32 offen
    buffer_load_dwordx4 v[84:87], v11, s[12:15], s33 offen
    s_mul_i32 s32, s7, 14336
    s_add_u32 s32, s32, s71
    s_add_u32 s33, s32, 7168
    s_add_u32 s7, s7, 1
    s_cmp_eq_u32 s7, 28
    s_cselect_b32 s7, 0, s7
    buffer_load_dwordx4 v[88:91], v11, s[12:15], s32 offen
    buffer_load_dwordx4 v[92:95], v11, s[12:15], s33 offen
    s_setprio 3
    v_mov_b32 v22, 153700
    v_mov_b32 v23, 1
    s_mov_b64 exec, 1
    ds_add_rtn_u32 v23, v22, v23
    s_mov_b64 exec, -1
    s_waitcnt lgkmcnt(0)
    v_readfirstlane_b32 s32, v23
    s_cmp_lg_u32 s32, 3
    s_cbranch_scc1 L_FS1
    s_mov_b64 exec, 0xff
    buffer_store_dwordx4 v[36:39], v2, s[8:11], s60 offen sc1
    s_mov_b64 exec, -1
L_FS1:
    s_setprio 0
    s_setprio 3
    s_mov_b32 s56, 1048576
L_PG2:
    ds_read_b32 v21, v35 offset:80
    s_sub_u32 s56, s56, 1
    s_cbranch_scc1 L_PGX2
    s_waitcnt lgkmcnt(0)
    v_cmp_gt_u32 vcc, 11, v21
    s_cbranch_vccz L_PGX2
    s_sleep 2
    s_branch L_PG2
L_PGX2:
    s_setprio 0
    s_waitcnt vmcnt(15)
    ds_write_b128 v17, v[44:47] offset:49152
    s_waitcnt vmcnt(14)
    ds_write_b128 v17, v[48:51] offset:50176
    s_waitcnt vmcnt(13)
    ds_write_b128 v17, v[52:55] offset:51200
    s_waitcnt vmcnt(12)
    ds_write_b128 v17, v[56:59] offset:52224
    s_waitcnt vmcnt(11)
    ds_write_b128 v17, v[60:63] offset:53248
    s_waitcnt vmcnt(10)
    ds_write_b128 v17, v[64:67] offset:54272
    s_waitcnt vmcnt(9)
    ds_write_b128 v17, v[68:71] offset:55296
    s_waitcnt vmcnt(8)
    ds_write_b128 v17, v[72:75] offset:56320
    s_waitcnt vmcnt(7)
    ds_write_b128 v18, v[76:79] offset:0
    s_waitcnt vmcnt(6)
    ds_write_b128 v18, v[24:27] offset:1024
    s_waitcnt vmcnt(5)
    ds_write_b128 v18, v[28:31] offset:2048
    s_waitcnt vmcnt(4)
    ds_write_b128 v18, v[40:43] offset:3072
    v_mov_b32 v21, 1
    ds_write_b32 v19, v21
    s_mul_i32 s32, s7, 14336
    s_add_u32 s32, s32, s71
    s_add_u32 s33, s32, 7168
    s_add_u32 s7, s7, 1
    s_cmp_eq_u32 s7, 28
    s_cselect_b32 s7, 0, s7
    buffer_load_dwordx4 v[96:99], v11, s[12:15], s32 offen
    buffer_load_dwordx4 v[100:103], v11, s[12:15], s33 offen
    s_mul_i32 s32, s7, 14336
    s_add_u32 s32, s32, s71
    s_add_u32 s33, s32, 7168
    s_add_u32 s7, s7, 1
    s_cmp_eq_u32 s7, 28
    s_cselect_b32 s7, 0, s7
    buffer_load_dwordx4 v[104:107], v11, s[12:15], s32 offen
    buffer_load_dwordx4 v[108:111], v11, s[12:15], s33 offen
    s_mul_i32 s32, s7, 14336
    s_add_u32 s32, s32, s71
    s_add_u32 s33, s32, 7168
    s_add_u32 s7, s7, 1
    s_cmp_eq_u32 s7, 28
    s_cselect_b32 s7, 0, s7
    buffer_load_dwordx4 v[112:115], v11, s[12:15], s32 offen
    buffer_load_dwordx4 v[116:119], v11, s[12:15], s33 offen
    s_mul_i32 s32, s7, 14336
    s_add_u32 s32, s32, s71
    s_add_u32 s33, s32, 7168
    s_add_u32 s7, s7, 1
    s_cmp_eq_u32 s7, 28
    s_cselect_b32 s7, 0, s7
    buffer_load_dwordx4 v[120:123], v11, s[12:15], s32 offen
    buffer_load_dwordx4 v[124:127], v11, s[12:15], s33 offen
    s_mul_i32 s32, s7, 14336
    s_add_u32 s32, s32, s71
    s_add_u32 s33, s32, 7168
    s_add_u32 s7, s7, 1
    s_cmp_eq_u32 s7, 28
    s_cselect_b32 s7, 0, s7
    buffer_load_dwordx4 v[128:131], v11, s[12:15], s32 offen
    buffer_load_dwordx4 v[132:135], v11, s[12:15], s33 offen
    s_mul_i32 s32, s7, 14336
    s_add_u32 s32, s32, s71
    s_add_u32 s33, s32, 7168
    s_add_u32 s7, s7, 1
    s_cmp_eq_u32 s7, 28
    s_cselect_b32 s7, 0, s7
    buffer_load_dwordx4 v[136:139], v11, s[12:15], s32 offen
    buffer_load_dwordx4 v[140:143], v11, s[12:15], s33 offen
    s_mul_i32 s32, s7, 14336
    s_add_u32 s32, s32, s71
    s_add_u32 s33, s32, 7168
    s_add_u32 s7, s7, 1
    s_cmp_eq_u32 s7, 28
    s_cselect_b32 s7, 0, s7
    buffer_load_dwordx4 v[144:147], v11, s[12:15], s32 offen
    buffer_load_dwordx4 v[148:151], v11, s[12:15], s33 offen
    s_mul_i32 s32, s7, 14336
    s_add_u32 s32, s32, s71
    s_add_u32 s33, s32, 7168
    s_add_u32 s7, s7, 1
    s_cmp_eq_u32 s7, 28
    s_cselect_b32 s7, 0, s7
    buffer_load_dwordx4 v[152:155], v11, s[12:15], s32 offen
    buffer_load_dwordx4 v[156:159], v11, s[12:15], s33 offen
    s_mul_i32 s32, s7, 14336
    s_add_u32 s32, s32, s71
    s_add_u32 s33, s32, 7168
    s_add_u32 s7, s7, 1
    s_cmp_eq_u32 s7, 28
    s_cselect_b32 s7, 0, s7
    buffer_load_dwordx4 v[160:163], v11, s[12:15], s32 offen
    buffer_load_dwordx4 v[164:167], v11, s[12:15], s33 offen
    s_mul_i32 s32, s7, 14336
    s_add_u32 s32, s32, s71
    s_add_u32 s33, s32, 7168
    s_add_u32 s7, s7, 1
    s_cmp_eq_u32 s7, 28
    s_cselect_b32 s7, 0, s7
    buffer_load_dwordx4 v[168:171], v11, s[12:15], s32 offen
    buffer_load_dwordx4 v[172:175], v11, s[12:15], s33 offen
    s_mul_i32 s32, s7, 14336
    s_add_u32 s32, s32, s71
    s_add_u32 s33, s32, 7168
    s_add_u32 s7, s7, 1
    s_cmp_eq_u32 s7, 28
    s_cselect_b32 s7, 0, s7
    buffer_load_dwordx4 v[176:179], v11, s[12:15], s32 offen
    buffer_load_dwordx4 v[180:183], v11, s[12:15], s33 offen
    s_mul_i32 s32, s7, 14336
    s_add_u32 s32, s32, s71
    s_add_u32 s33, s32, 7168
    s_add_u32 s7, s7, 1
    s_cmp_eq_u32 s7, 28
    s_cselect_b32 s7, 0, s7
    buffer_load_dwordx4 v[184:187], v11, s[12:15], s32 offen
    buffer_load_dwordx4 v[188:191], v11, s[12:15], s33 offen
    s_mul_i32 s32, s7, 14336
    s_add_u32 s32, s32, s71
    s_add_u32 s33, s32, 7168
    s_add_u32 s7, s7, 1
    s_cmp_eq_u32 s7, 28
    s_cselect_b32 s7, 0, s7
    buffer_load_dwordx4 v[192:195], v11, s[12:15], s32 offen
    buffer_load_dwordx4 v[196:199], v11, s[12:15], s33 offen
    s_mul_i32 s32, s7, 14336
    s_add_u32 s32, s32, s71
    s_add_u32 s33, s32, 7168
    s_add_u32 s7, s7, 1
    s_cmp_eq_u32 s7, 28
    s_cselect_b32 s7, 0, s7
    buffer_load_dwordx4 v[200:203], v11, s[12:15], s32 offen
    buffer_load_dwordx4 v[204:207], v11, s[12:15], s33 offen
    s_lshr_b32 s32, s64, 1
    s_mul_i32 s65, s32, 18
    s_add_u32 s65, s65, s101
    s_lshl_b32 s65, s65, 4
    s_and_b32 s33, s64, 1
    s_add_u32 s65, s65, s33
    s_lshl_b32 s65, s65, 10
    s_add_u32 s65, s65, 0x600000
    s_cmp_ge_u32 s101, 14
    s_cselect_b32 s65, 0x4000000, s65
    s_setprio 3
    s_mov_b32 s56, 1048576
L_BL0:
    ds_read_b32 v21, v19 offset:16
    s_sub_u32 s56, s56, 1
    s_cbranch_scc1 L_BLX0
    s_waitcnt lgkmcnt(0)
    v_readfirstlane_b32 s32, v21
    s_cmp_ge_u32 s32, 1
    s_cbranch_scc1 L_BLX0
    s_sleep 1
    s_branch L_BL0
L_BLX0:
    s_setprio 0
    ds_read_b128 v[44:47], v20 offset:0
    ds_read_b128 v[48:51], v20 offset:1024
    ds_read_b128 v[52:55], v20 offset:2048
    ds_read_b128 v[56:59], v20 offset:3072
    ds_read_b128 v[60:63], v20 offset:4096
    ds_read_b128 v[64:67], v20 offset:5120
    ds_read_b128 v[68:71], v20 offset:6144
    ds_read_b128 v[72:75], v20 offset:7168
    s_waitcnt lgkmcnt(7)
    buffer_store_dwordx4 v[44:47], v2, s[8:11], s65 offen offset:0 sc1
    s_waitcnt lgkmcnt(6)
    buffer_store_dwordx4 v[48:51], v2, s[8:11], s65 offen offset:2048 sc1
    s_add_u32 s65, s65, 4096
    s_waitcnt lgkmcnt(5)
    buffer_store_dwordx4 v[52:55], v2, s[8:11], s65 offen offset:0 sc1
    s_waitcnt lgkmcnt(4)
    buffer_store_dwordx4 v[56:59], v2, s[8:11], s65 offen offset:2048 sc1
    s_add_u32 s65, s65, 4096
    s_waitcnt lgkmcnt(3)
    buffer_store_dwordx4 v[60:63], v2, s[8:11], s65 offen offset:0 sc1
    s_waitcnt lgkmcnt(2)
    buffer_store_dwordx4 v[64:67], v2, s[8:11], s65 offen offset:2048 sc1
    s_add_u32 s65, s65, 4096
    s_waitcnt lgkmcnt(1)
    buffer_store_dwordx4 v[68:71], v2, s[8:11], s65 offen offset:0 sc1
    s_waitcnt lgkmcnt(0)
    buffer_store_dwordx4 v[72:75], v2, s[8:11], s65 offen offset:2048 sc1
    s_waitcnt vmcnt(38)
    ds_write_b128 v12, v[80:83] offset:0
    ds_write_b128 v12, v[84:87] offset:1024
    ds_read_b64_tr_b16 v[80:81], v10 offset:0
    ds_read_b64_tr_b16 v[82:83], v10 offset:1024
    ds_read_b64_tr_b16 v[84:85], v10 offset:256
    ds_read_b64_tr_b16 v[86:87], v10 offset:1280
    s_waitcnt lgkmcnt(6)
    s_waitcnt vmcnt(36)
    ds_write_b128 v12, v[88:91] offset:0
    ds_write_b128 v12, v[92:95] offset:1024
    ds_read_b64_tr_b16 v[88:89], v10 offset:0
    ds_read_b64_tr_b16 v[90:91], v10 offset:1024
    ds_read_b64_tr_b16 v[92:93], v10 offset:256
    ds_read_b64_tr_b16 v[94:95], v10 offset:1280
    s_waitcnt lgkmcnt(6)
    s_waitcnt vmcnt(34)
    ds_write_b128 v12, v[96:99] offset:0
    ds_write_b128 v12, v[100:103] offset:1024
    ds_read_b64_tr_b16 v[96:97], v10 offset:0
    ds_read_b64_tr_b16 v[98:99], v10 offset:1024
    ds_read_b64_tr_b16 v[100:101], v10 offset:256
    ds_read_b64_tr_b16 v[102:103], v10 offset:1280
    s_waitcnt lgkmcnt(6)
    s_waitcnt vmcnt(32)
    ds_write_b128 v12, v[104:107] offset:0
    ds_write_b128 v12, v[108:111] offset:1024
    ds_read_b64_tr_b16 v[104:105], v10 offset:0
    ds_read_b64_tr_b16 v[106:107], v10 offset:1024
    ds_read_b64_tr_b16 v[108:109], v10 offset:256
    ds_read_b64_tr_b16 v[110:111], v10 offset:1280
    s_waitcnt lgkmcnt(6)
    s_waitcnt vmcnt(30)
    ds_write_b128 v12, v[112:115] offset:0
    ds_write_b128 v12, v[116:119] offset:1024
    ds_read_b64_tr_b16 v[112:113], v10 offset:0
    ds_read_b64_tr_b16 v[114:115], v10 offset:1024
    ds_read_b64_tr_b16 v[116:117], v10 offset:256
    ds_read_b64_tr_b16 v[118:119], v10 offset:1280
    s_waitcnt lgkmcnt(6)
    s_waitcnt vmcnt(0)
    s_setprio 3
    v_mov_b32 v22, 153704
    v_mov_b32 v23, 1
    s_mov_b64 exec, 1
    ds_add_rtn_u32 v23, v22, v23
    s_mov_b64 exec, -1
    s_waitcnt lgkmcnt(0)
    v_readfirstlane_b32 s32, v23
    s_cmp_lg_u32 s32, 3
    s_cbranch_scc1 L_FS2
    s_mov_b64 exec, 0xff
    buffer_store_dwordx4 v[36:39], v2, s[8:11], s66 offen sc1
    s_mov_b64 exec, -1
L_FS2:
    s_setprio 0
    s_setprio 0
    s_cmp_ge_u32 s5, 7
    s_cbranch_scc1 L_END
    s_and_b32 s32, s28, 1
    s_lshl_b32 s32, s32, 10
    v_add_u32 v14, s32, v2
    v_xor_b32 v15, 1024, v14
    v_and_b32 v3, 31, v1
    v_mul_u32_u24 v3, 896, v3
    v_lshl_add_u32 v0, v4, 4, v3
    v_lshl_add_u32 v3, v4, 3, v3
    s_lshl_b32 s60, s4, 1
    s_and_b32 s32, s28, 1
    s_add_u32 s60, s60, s32
    s_mul_i32 s60, s60, 28672
    s_lshl_b32 s32, s5, 1
    s_lshr_b32 s33, s28, 1
    s_add_u32 s32, s32, s33
    s_lshl_b32 s32, s32, 6
    s_add_u32 s60, s60, s32
    s_mov_b32 s16, s40
    s_mov_b32 s17, s41
    s_mov_b32 s18, 0x1c0000
    s_mov_b32 s19, 0x00020000
    s_mul_i32 s32, s28, 28
    s_mul_i32 s63, s4, 144
    s_add_u32 s63, s63, s32
    s_lshl_b32 s63, s63, 11
    s_add_u32 s63, s63, 0x600000
    s_lshl_b32 s6, s6, 11
    buffer_load_dwordx2 v[208:209], v3, s[16:19], s60 offen offset:0
    buffer_load_dwordx2 v[210:211], v3, s[16:19], s60 offen offset:16
    buffer_load_dwordx2 v[212:213], v3, s[16:19], s60 offen offset:32
    buffer_load_dwordx2 v[214:215], v3, s[16:19], s60 offen offset:48
    ds_write_b128 v12, v[120:123] offset:0
    ds_write_b128 v12, v[124:127] offset:1024
    ds_read_b64_tr_b16 v[120:121], v10 offset:0
    ds_read_b64_tr_b16 v[122:123], v10 offset:1024
    ds_read_b64_tr_b16 v[124:125], v10 offset:256
    ds_read_b64_tr_b16 v[126:127], v10 offset:1280
    s_waitcnt lgkmcnt(6)
    ds_write_b128 v12, v[128:131] offset:0
    ds_write_b128 v12, v[132:135] offset:1024
    ds_read_b64_tr_b16 v[128:129], v10 offset:0
    ds_read_b64_tr_b16 v[130:131], v10 offset:1024
    ds_read_b64_tr_b16 v[132:133], v10 offset:256
    ds_read_b64_tr_b16 v[134:135], v10 offset:1280
    s_waitcnt lgkmcnt(6)
    ds_write_b128 v12, v[136:139] offset:0
    ds_write_b128 v12, v[140:143] offset:1024
    ds_read_b64_tr_b16 v[136:137], v10 offset:0
    ds_read_b64_tr_b16 v[138:139], v10 offset:1024
    ds_read_b64_tr_b16 v[140:141], v10 offset:256
    ds_read_b64_tr_b16 v[142:143], v10 offset:1280
    s_waitcnt lgkmcnt(6)
    ds_write_b128 v12, v[144:147] offset:0
    ds_write_b128 v12, v[148:151] offset:1024
    ds_read_b64_tr_b16 v[144:145], v10 offset:0
    ds_read_b64_tr_b16 v[146:147], v10 offset:1024
    ds_read_b64_tr_b16 v[148:149], v10 offset:256
    ds_read_b64_tr_b16 v[150:151], v10 offset:1280
    s_waitcnt lgkmcnt(6)
    ds_write_b128 v12, v[152:155] offset:0
    ds_write_b128 v12, v[156:159] offset:1024
    ds_read_b64_tr_b16 v[152:153], v10 offset:0
    ds_read_b64_tr_b16 v[154:155], v10 offset:1024
    ds_read_b64_tr_b16 v[156:157], v10 offset:256
    ds_read_b64_tr_b16 v[158:159], v10 offset:1280
    s_waitcnt lgkmcnt(6)
    ds_write_b128 v12, v[160:163] offset:0
    ds_write_b128 v12, v[164:167] offset:1024
    ds_read_b64_tr_b16 v[160:161], v10 offset:0
    ds_read_b64_tr_b16 v[162:163], v10 offset:1024
    ds_read_b64_tr_b16 v[164:165], v10 offset:256
    ds_read_b64_tr_b16 v[166:167], v10 offset:1280
    s_waitcnt lgkmcnt(6)
    ds_write_b128 v12, v[168:171] offset:0
    ds_write_b128 v12, v[172:175] offset:1024
    ds_read_b64_tr_b16 v[168:169], v10 offset:0
    ds_read_b64_tr_b16 v[170:171], v10 offset:1024
    ds_read_b64_tr_b16 v[172:173], v10 offset:256
    ds_read_b64_tr_b16 v[174:175], v10 offset:1280
    s_waitcnt lgkmcnt(6)
    ds_write_b128 v12, v[176:179] offset:0
    ds_write_b128 v12, v[180:183] offset:1024
    ds_read_b64_tr_b16 v[176:177], v10 offset:0
    ds_read_b64_tr_b16 v[178:179], v10 offset:1024
    ds_read_b64_tr_b16 v[180:181], v10 offset:256
    ds_read_b64_tr_b16 v[182:183], v10 offset:1280
    s_waitcnt lgkmcnt(6)
    ds_write_b128 v12, v[184:187] offset:0
    ds_write_b128 v12, v[188:191] offset:1024
    ds_read_b64_tr_b16 v[184:185], v10 offset:0
    ds_read_b64_tr_b16 v[186:187], v10 offset:1024
    ds_read_b64_tr_b16 v[188:189], v10 offset:256
    ds_read_b64_tr_b16 v[190:191], v10 offset:1280
    s_waitcnt lgkmcnt(6)
    ds_write_b128 v12, v[192:195] offset:0
    ds_write_b128 v12, v[196:199] offset:1024
    ds_read_b64_tr_b16 v[192:193], v10 offset:0
    ds_read_b64_tr_b16 v[194:195], v10 offset:1024
    ds_read_b64_tr_b16 v[196:197], v10 offset:256
    ds_read_b64_tr_b16 v[198:199], v10 offset:1280
    s_waitcnt lgkmcnt(6)
    ds_write_b128 v12, v[200:203] offset:0
    ds_write_b128 v12, v[204:207] offset:1024
    ds_read_b64_tr_b16 v[200:201], v10 offset:0
    ds_read_b64_tr_b16 v[202:203], v10 offset:1024
    ds_read_b64_tr_b16 v[204:205], v10 offset:256
    ds_read_b64_tr_b16 v[206:207], v10 offset:1280
    s_waitcnt lgkmcnt(6)
    s_waitcnt vmcnt(0)
    v_lshlrev_b32 v16, 16, v208
    v_and_b32 v17, s35, v208
    v_lshlrev_b32 v18, 16, v209
    v_and_b32 v19, s35, v209
    v_lshlrev_b32 v20, 16, v210
    v_and_b32 v21, s35, v210
    v_lshlrev_b32 v22, 16, v211
    v_and_b32 v23, s35, v211
    v_lshlrev_b32 v24, 16, v212
    v_and_b32 v25, s35, v212
    v_lshlrev_b32 v26, 16, v213
    v_and_b32 v27, s35, v213
    v_lshlrev_b32 v28, 16, v214
    v_and_b32 v29, s35, v214
    v_lshlrev_b32 v30, 16, v215
    v_and_b32 v31, s35, v215
    s_waitcnt lgkmcnt(0)
    v_lshlrev_b32 v9, 7, v7
    s_lshr_b32 s61, s4, 1
    s_lshl_b32 s61, s61, 11
    s_mul_i32 s32, s28, 7
    s_lshr_b32 s32, s32, 1
    s_lshl_b32 s32, s32, 7
    s_add_u32 s57, s61, s32
    s_add_u32 s57, s57, 0x8000
    s_lshl_b32 s33, s28, 9
    s_sub_u32 s33, s33, s32
    s_add_u32 s33, s33, 0x8000
    v_bfe_u32 v218, v1, 2, 1
    v_mul_lo_u32 v218, v218, s33
    v_add_u32 v9, v9, v218
    s_mov_b32 s20, s44
    s_mov_b32 s21, s45
    s_mov_b32 s22, 0x62000
    s_mov_b32 s23, 0x00020000
    v_mov_b32 v12, 153600
    s_setprio 3
    s_mov_b32 s56, 1048576
L_BL1:
    ds_read_b32 v10, v12 offset:0
    s_sub_u32 s56, s56, 1
    s_cbranch_scc1 L_BLX1
    s_waitcnt lgkmcnt(0)
    v_readfirstlane_b32 s32, v10
    s_cmp_ge_u32 s32, 4
    s_cbranch_scc1 L_BLX1
    s_sleep 1
    s_branch L_BL1
L_BLX1:
    s_setprio 0
    s_mul_i32 s32, s7, 14336
    s_add_u32 s32, s32, s71
    s_add_u32 s33, s32, 7168
    s_add_u32 s7, s7, 1
    s_cmp_eq_u32 s7, 28
    s_cselect_b32 s7, 0, s7
    s_add_u32 m0, s70, 0
    s_nop 0
    buffer_load_dwordx4 v11, s[12:15], s32 offen lds
    s_add_u32 m0, s70, 1024
    s_nop 0
    buffer_load_dwordx4 v11, s[12:15], s33 offen lds
    s_mul_i32 s32, s7, 14336
    s_add_u32 s32, s32, s71
    s_add_u32 s33, s32, 7168
    s_add_u32 s7, s7, 1
    s_cmp_eq_u32 s7, 28
    s_cselect_b32 s7, 0, s7
    s_add_u32 m0, s70, 2048
    s_nop 0
    buffer_load_dwordx4 v11, s[12:15], s32 offen lds
    s_add_u32 m0, s70, 3072
    s_nop 0
    buffer_load_dwordx4 v11, s[12:15], s33 offen lds
    s_setprio 3
    s_mov_b32 s56, 131072
L_BP1:
    buffer_load_dwordx2 v[216:217], v9, s[8:11], s57 offen sc1
    s_sub_u32 s56, s56, 1
    s_cbranch_scc1 L_BPX1
    s_waitcnt vmcnt(0)
    v_cmp_ne_u64 vcc, s[58:59], v[216:217]
    s_cbranch_vccz L_BPX1
    s_sleep 2
    s_branch L_BP1
L_BPX1:
    s_setprio 0
    s_setprio 0
    s_add_u32 s62, s63, s6
    buffer_load_dwordx4 v[208:211], v14, s[8:11], s62 offen sc1
    buffer_load_dwordx4 v[212:215], v15, s[8:11], s62 offen sc1
    s_add_u32 s6, s6, 2048
    s_cmp_eq_u32 s6, 57344
    s_cselect_b32 s6, 0, s6
    s_add_u32 s62, s63, s6
    buffer_load_dwordx4 v[216:219], v14, s[8:11], s62 offen sc1
    buffer_load_dwordx4 v[220:223], v15, s[8:11], s62 offen sc1
    s_add_u32 s6, s6, 2048
    s_cmp_eq_u32 s6, 57344
    s_cselect_b32 s6, 0, s6
    s_add_u32 s62, s63, s6
    buffer_load_dwordx4 v[224:227], v14, s[8:11], s62 offen sc1
    buffer_load_dwordx4 v[228:231], v15, s[8:11], s62 offen sc1
    s_add_u32 s6, s6, 2048
    s_cmp_eq_u32 s6, 57344
    s_cselect_b32 s6, 0, s6
    s_add_u32 s62, s63, s6
    buffer_load_dwordx4 v[232:235], v14, s[8:11], s62 offen sc1
    buffer_load_dwordx4 v[236:239], v15, s[8:11], s62 offen sc1
    s_add_u32 s6, s6, 2048
    s_cmp_eq_u32 s6, 57344
    s_cselect_b32 s6, 0, s6
    s_add_u32 s62, s63, s6
    buffer_load_dwordx4 v[240:243], v14, s[8:11], s62 offen sc1
    buffer_load_dwordx4 v[244:247], v15, s[8:11], s62 offen sc1
    s_add_u32 s6, s6, 2048
    s_cmp_eq_u32 s6, 57344
    s_cselect_b32 s6, 0, s6
    s_waitcnt vmcnt(8)
    v_mfma_f32_32x32x16_bf16 v[16:31], v[80:83], v[208:211], v[16:31]
    s_add_u32 s62, s63, s6
    buffer_load_dwordx4 v[248:251], v14, s[8:11], s62 offen sc1
    buffer_load_dwordx4 v[252:255], v15, s[8:11], s62 offen sc1
    s_add_u32 s6, s6, 2048
    s_cmp_eq_u32 s6, 57344
    s_cselect_b32 s6, 0, s6
    v_mfma_f32_32x32x16_bf16 v[32:47], v[80:83], v[212:215], 0
    v_mfma_f32_32x32x16_bf16 v[48:63], v[84:87], v[208:211], 0
    v_mfma_f32_32x32x16_bf16 v[64:79], v[84:87], v[212:215], 0
    s_mul_i32 s32, s7, 14336
    s_add_u32 s32, s32, s71
    s_add_u32 s33, s32, 7168
    s_add_u32 s7, s7, 1
    s_cmp_eq_u32 s7, 28
    s_cselect_b32 s7, 0, s7
    s_add_u32 m0, s70, 4096
    s_nop 0
    buffer_load_dwordx4 v11, s[12:15], s32 offen lds
    s_add_u32 m0, s70, 5120
    s_nop 0
    buffer_load_dwordx4 v11, s[12:15], s33 offen lds
    s_waitcnt vmcnt(10)
    v_mfma_f32_32x32x16_bf16 v[16:31], v[88:91], v[216:219], v[16:31]
    s_add_u32 s62, s63, s6
    buffer_load_dwordx4 v[208:211], v14, s[8:11], s62 offen sc1
    buffer_load_dwordx4 v[212:215], v15, s[8:11], s62 offen sc1
    s_add_u32 s6, s6, 2048
    s_cmp_eq_u32 s6, 57344
    s_cselect_b32 s6, 0, s6
    v_mfma_f32_32x32x16_bf16 v[32:47], v[88:91], v[220:223], v[32:47]
    v_mfma_f32_32x32x16_bf16 v[48:63], v[92:95], v[216:219], v[48:63]
    v_mfma_f32_32x32x16_bf16 v[64:79], v[92:95], v[220:223], v[64:79]
    s_mul_i32 s32, s7, 14336
    s_add_u32 s32, s32, s71
    s_add_u32 s33, s32, 7168
    s_add_u32 s7, s7, 1
    s_cmp_eq_u32 s7, 28
    s_cselect_b32 s7, 0, s7
    s_add_u32 m0, s70, 6144
    s_nop 0
    buffer_load_dwordx4 v11, s[12:15], s32 offen lds
    s_add_u32 m0, s70, 7168
    s_nop 0
    buffer_load_dwordx4 v11, s[12:15], s33 offen lds
    s_waitcnt vmcnt(12)
    v_mfma_f32_32x32x16_bf16 v[16:31], v[96:99], v[224:227], v[16:31]
    s_add_u32 s62, s63, s6
    buffer_load_dwordx4 v[216:219], v14, s[8:11], s62 offen sc1
    buffer_load_dwordx4 v[220:223], v15, s[8:11], s62 offen sc1
    s_add_u32 s6, s6, 2048
    s_cmp_eq_u32 s6, 57344
    s_cselect_b32 s6, 0, s6
    v_mfma_f32_32x32x16_bf16 v[32:47], v[96:99], v[228:231], v[32:47]
    v_mfma_f32_32x32x16_bf16 v[48:63], v[100:103], v[224:227], v[48:63]
    v_mfma_f32_32x32x16_bf16 v[64:79], v[100:103], v[228:231], v[64:79]
    s_mul_i32 s32, s7, 14336
    s_add_u32 s32, s32, s71
    s_add_u32 s33, s32, 7168
    s_add_u32 s7, s7, 1
    s_cmp_eq_u32 s7, 28
    s_cselect_b32 s7, 0, s7
    s_add_u32 m0, s70, 32768
    s_nop 0
    buffer_load_dwordx4 v11, s[12:15], s32 offen lds
    s_add_u32 m0, s70, 33792
    s_nop 0
    buffer_load_dwordx4 v11, s[12:15], s33 offen lds
    s_waitcnt vmcnt(14)
    v_mfma_f32_32x32x16_bf16 v[16:31], v[104:107], v[232:235], v[16:31]
    s_add_u32 s62, s63, s6
    buffer_load_dwordx4 v[224:227], v14, s[8:11], s62 offen sc1
    buffer_load_dwordx4 v[228:231], v15, s[8:11], s62 offen sc1
    s_add_u32 s6, s6, 2048
    s_cmp_eq_u32 s6, 57344
    s_cselect_b32 s6, 0, s6
    v_mfma_f32_32x32x16_bf16 v[32:47], v[104:107], v[236:239], v[32:47]
    v_mfma_f32_32x32x16_bf16 v[48:63], v[108:111], v[232:235], v[48:63]
    v_mfma_f32_32x32x16_bf16 v[64:79], v[108:111], v[236:239], v[64:79]
    s_mul_i32 s32, s7, 14336
    s_add_u32 s32, s32, s71
    s_add_u32 s33, s32, 7168
    s_add_u32 s7, s7, 1
    s_cmp_eq_u32 s7, 28
    s_cselect_b32 s7, 0, s7
    s_add_u32 m0, s70, 34816
    s_nop 0
    buffer_load_dwordx4 v11, s[12:15], s32 offen lds
    s_add_u32 m0, s70, 35840
    s_nop 0
    buffer_load_dwordx4 v11, s[12:15], s33 offen lds
    s_waitcnt vmcnt(16)
    v_mfma_f32_32x32x16_bf16 v[16:31], v[112:115], v[240:243], v[16:31]
    s_add_u32 s62, s63, s6
    buffer_load_dwordx4 v[232:235], v14, s[8:11], s62 offen sc1
    buffer_load_dwordx4 v[236:239], v15, s[8:11], s62 offen sc1
    s_add_u32 s6, s6, 2048
    s_cmp_eq_u32 s6, 57344
    s_cselect_b32 s6, 0, s6
    v_mfma_f32_32x32x16_bf16 v[32:47], v[112:115], v[244:247], v[32:47]
    v_mfma_f32_32x32x16_bf16 v[48:63], v[116:119], v[240:243], v[48:63]
    v_mfma_f32_32x32x16_bf16 v[64:79], v[116:119], v[244:247], v[64:79]
    s_mul_i32 s32, s7, 14336
    s_add_u32 s32, s32, s71
    s_add_u32 s33, s32, 7168
    s_add_u32 s7, s7, 1
    s_cmp_eq_u32 s7, 28
    s_cselect_b32 s7, 0, s7
    s_add_u32 m0, s70, 36864
    s_nop 0
    buffer_load_dwordx4 v11, s[12:15], s32 offen lds
    s_add_u32 m0, s70, 37888
    s_nop 0
    buffer_load_dwordx4 v11, s[12:15], s33 offen lds
    s_waitcnt vmcnt(18)
    v_mfma_f32_32x32x16_bf16 v[16:31], v[120:123], v[248:251], v[16:31]
    s_add_u32 s62, s63, s6
    buffer_load_dwordx4 v[240:243], v14, s[8:11], s62 offen sc1
    buffer_load_dwordx4 v[244:247], v15, s[8:11], s62 offen sc1
    s_add_u32 s6, s6, 2048
    s_cmp_eq_u32 s6, 57344
    s_cselect_b32 s6, 0, s6
    v_mfma_f32_32x32x16_bf16 v[32:47], v[120:123], v[252:255], v[32:47]
    v_mfma_f32_32x32x16_bf16 v[48:63], v[124:127], v[248:251], v[48:63]
    v_mfma_f32_32x32x16_bf16 v[64:79], v[124:127], v[252:255], v[64:79]
    s_mul_i32 s32, s7, 14336
    s_add_u32 s32, s32, s71
    s_add_u32 s33, s32, 7168
    s_add_u32 s7, s7, 1
    s_cmp_eq_u32 s7, 28
    s_cselect_b32 s7, 0, s7
    s_add_u32 m0, s70, 38912
    s_nop 0
    buffer_load_dwordx4 v11, s[12:15], s32 offen lds
    s_add_u32 m0, s70, 39936
    s_nop 0
    buffer_load_dwordx4 v11, s[12:15], s33 offen lds
    s_waitcnt vmcnt(18)
    v_mfma_f32_32x32x16_bf16 v[16:31], v[128:131], v[208:211], v[16:31]
    s_add_u32 s62, s63, s6
    buffer_load_dwordx4 v[248:251], v14, s[8:11], s62 offen sc1
    buffer_load_dwordx4 v[252:255], v15, s[8:11], s62 offen sc1
    s_add_u32 s6, s6, 2048
    s_cmp_eq_u32 s6, 57344
    s_cselect_b32 s6, 0, s6
    v_mfma_f32_32x32x16_bf16 v[32:47], v[128:131], v[212:215], v[32:47]
    ds_read_b64_tr_b16 v[80:81], v13 offset:0
    ds_read_b64_tr_b16 v[82:83], v13 offset:1024
    ds_read_b64_tr_b16 v[84:85], v13 offset:256
    ds_read_b64_tr_b16 v[86:87], v13 offset:1280
    v_mfma_f32_32x32x16_bf16 v[48:63], v[132:135], v[208:211], v[48:63]
    v_mfma_f32_32x32x16_bf16 v[64:79], v[132:135], v[212:215], v[64:79]
    s_waitcnt lgkmcnt(0)
    s_mul_i32 s32, s7, 14336
    s_add_u32 s32, s32, s71
    s_add_u32 s33, s32, 7168
    s_add_u32 s7, s7, 1
    s_cmp_eq_u32 s7, 28
    s_cselect_b32 s7, 0, s7
    s_add_u32 m0, s70, 0
    s_nop 0
    buffer_load_dwordx4 v11, s[12:15], s32 offen lds
    s_add_u32 m0, s70, 1024
    s_nop 0
    buffer_load_dwordx4 v11, s[12:15], s33 offen lds
    s_waitcnt vmcnt(18)
    v_mfma_f32_32x32x16_bf16 v[16:31], v[136:139], v[216:219], v[16:31]
    s_add_u32 s62, s63, s6
    buffer_load_dwordx4 v[208:211], v14, s[8:11], s62 offen sc1
    buffer_load_dwordx4 v[212:215], v15, s[8:11], s62 offen sc1
    s_add_u32 s6, s6, 2048
    s_cmp_eq_u32 s6, 57344
    s_cselect_b32 s6, 0, s6
    v_mfma_f32_32x32x16_bf16 v[32:47], v[136:139], v[220:223], v[32:47]
    ds_read_b64_tr_b16 v[88:89], v13 offset:2048
    ds_read_b64_tr_b16 v[90:91], v13 offset:3072
    ds_read_b64_tr_b16 v[92:93], v13 offset:2304
    ds_read_b64_tr_b16 v[94:95], v13 offset:3328
    v_mfma_f32_32x32x16_bf16 v[48:63], v[140:143], v[216:219], v[48:63]
    v_mfma_f32_32x32x16_bf16 v[64:79], v[140:143], v[220:223], v[64:79]
    s_waitcnt lgkmcnt(0)
    s_mul_i32 s32, s7, 14336
    s_add_u32 s32, s32, s71
    s_add_u32 s33, s32, 7168
    s_add_u32 s7, s7, 1
    s_cmp_eq_u32 s7, 28
    s_cselect_b32 s7, 0, s7
    s_add_u32 m0, s70, 2048
    s_nop 0
    buffer_load_dwordx4 v11, s[12:15], s32 offen lds
    s_add_u32 m0, s70, 3072
    s_nop 0
    buffer_load_dwordx4 v11, s[12:15], s33 offen lds
    s_waitcnt vmcnt(18)
    v_mfma_f32_32x32x16_bf16 v[16:31], v[144:147], v[224:227], v[16:31]
    s_add_u32 s62, s63, s6
    buffer_load_dwordx4 v[216:219], v14, s[8:11], s62 offen sc1
    buffer_load_dwordx4 v[220:223], v15, s[8:11], s62 offen sc1
    s_add_u32 s6, s6, 2048
    s_cmp_eq_u32 s6, 57344
    s_cselect_b32 s6, 0, s6
    v_mfma_f32_32x32x16_bf16 v[32:47], v[144:147], v[228:231], v[32:47]
    ds_read_b64_tr_b16 v[96:97], v13 offset:4096
    ds_read_b64_tr_b16 v[98:99], v13 offset:5120
    ds_read_b64_tr_b16 v[100:101], v13 offset:4352
    ds_read_b64_tr_b16 v[102:103], v13 offset:5376
    v_mfma_f32_32x32x16_bf16 v[48:63], v[148:151], v[224:227], v[48:63]
    v_mfma_f32_32x32x16_bf16 v[64:79], v[148:151], v[228:231], v[64:79]
    s_waitcnt lgkmcnt(0)
    s_mul_i32 s32, s7, 14336
    s_add_u32 s32, s32, s71
    s_add_u32 s33, s32, 7168
    s_add_u32 s7, s7, 1
    s_cmp_eq_u32 s7, 28
    s_cselect_b32 s7, 0, s7
    s_add_u32 m0, s70, 4096
    s_nop 0
    buffer_load_dwordx4 v11, s[12:15], s32 offen lds
    s_add_u32 m0, s70, 5120
    s_nop 0
    buffer_load_dwordx4 v11, s[12:15], s33 offen lds
    s_waitcnt vmcnt(18)
    v_mfma_f32_32x32x16_bf16 v[16:31], v[152:155], v[232:235], v[16:31]
    s_add_u32 s62, s63, s6
    buffer_load_dwordx4 v[224:227], v14, s[8:11], s62 offen sc1
    buffer_load_dwordx4 v[228:231], v15, s[8:11], s62 offen sc1
    s_add_u32 s6, s6, 2048
    s_cmp_eq_u32 s6, 57344
    s_cselect_b32 s6, 0, s6
    v_mfma_f32_32x32x16_bf16 v[32:47], v[152:155], v[236:239], v[32:47]
    ds_read_b64_tr_b16 v[104:105], v13 offset:6144
    ds_read_b64_tr_b16 v[106:107], v13 offset:7168
    ds_read_b64_tr_b16 v[108:109], v13 offset:6400
    ds_read_b64_tr_b16 v[110:111], v13 offset:7424
    v_mfma_f32_32x32x16_bf16 v[48:63], v[156:159], v[232:235], v[48:63]
    v_mfma_f32_32x32x16_bf16 v[64:79], v[156:159], v[236:239], v[64:79]
    s_waitcnt lgkmcnt(0)
    s_mul_i32 s32, s7, 14336
    s_add_u32 s32, s32, s71
    s_add_u32 s33, s32, 7168
    s_add_u32 s7, s7, 1
    s_cmp_eq_u32 s7, 28
    s_cselect_b32 s7, 0, s7
    s_add_u32 m0, s70, 6144
    s_nop 0
    buffer_load_dwordx4 v11, s[12:15], s32 offen lds
    s_add_u32 m0, s70, 7168
    s_nop 0
    buffer_load_dwordx4 v11, s[12:15], s33 offen lds
    s_waitcnt vmcnt(18)
    v_mfma_f32_32x32x16_bf16 v[16:31], v[160:163], v[240:243], v[16:31]
    s_add_u32 s62, s63, s6
    buffer_load_dwordx4 v[232:235], v14, s[8:11], s62 offen sc1
    buffer_load_dwordx4 v[236:239], v15, s[8:11], s62 offen sc1
    s_add_u32 s6, s6, 2048
    s_cmp_eq_u32 s6, 57344
    s_cselect_b32 s6, 0, s6
    v_mfma_f32_32x32x16_bf16 v[32:47], v[160:163], v[244:247], v[32:47]
    ds_read_b64_tr_b16 v[112:113], v13 offset:32768
    ds_read_b64_tr_b16 v[114:115], v13 offset:33792
    ds_read_b64_tr_b16 v[116:117], v13 offset:33024
    ds_read_b64_tr_b16 v[118:119], v13 offset:34048
    v_mfma_f32_32x32x16_bf16 v[48:63], v[164:167], v[240:243], v[48:63]
    v_mfma_f32_32x32x16_bf16 v[64:79], v[164:167], v[244:247], v[64:79]
    s_waitcnt lgkmcnt(0)
    s_mul_i32 s32, s28, 100352
    s_lshl_b32 s33, s5, 7
    s_add_u32 s32, s32, s33
    s_add_u32 s32, s32, 0
    s_add_u32 s33, s32, 7168
    s_add_u32 m0, s70, 32768
    s_nop 0
    buffer_load_dwordx4 v11, s[20:23], s32 offen lds
    s_add_u32 m0, s70, 33792
    s_nop 0
    buffer_load_dwordx4 v8, s[20:23], s33 offen lds
    s_waitcnt vmcnt(18)
    v_mfma_f32_32x32x16_bf16 v[16:31], v[168:171], v[248:251], v[16:31]
    s_add_u32 s62, s63, s6
    buffer_load_dwordx4 v[240:243], v14, s[8:11], s62 offen sc1
    buffer_load_dwordx4 v[244:247], v15, s[8:11], s62 offen sc1
    s_add_u32 s6, s6, 2048
    s_cmp_eq_u32 s6, 57344
    s_cselect_b32 s6, 0, s6
    v_mfma_f32_32x32x16_bf16 v[32:47], v[168:171], v[252:255], v[32:47]
    ds_read_b64_tr_b16 v[120:121], v13 offset:34816
    ds_read_b64_tr_b16 v[122:123], v13 offset:35840
    ds_read_b64_tr_b16 v[124:125], v13 offset:35072
    ds_read_b64_tr_b16 v[126:127], v13 offset:36096
    v_mfma_f32_32x32x16_bf16 v[48:63], v[172:175], v[248:251], v[48:63]
    v_mfma_f32_32x32x16_bf16 v[64:79], v[172:175], v[252:255], v[64:79]
    s_waitcnt lgkmcnt(0)
    s_mul_i32 s32, s28, 100352
    s_lshl_b32 s33, s5, 7
    s_add_u32 s32, s32, s33
    s_add_u32 s32, s32, 12544
    s_add_u32 s33, s32, 7168
    s_add_u32 m0, s70, 34816
    s_nop 0
    buffer_load_dwordx4 v11, s[20:23], s32 offen lds
    s_add_u32 m0, s70, 35840
    s_nop 0
    buffer_load_dwordx4 v8, s[20:23], s33 offen lds
    s_waitcnt vmcnt(18)
    v_mfma_f32_32x32x16_bf16 v[16:31], v[176:179], v[208:211], v[16:31]
    s_add_u32 s62, s63, s6
    buffer_load_dwordx4 v[248:251], v14, s[8:11], s62 offen sc1
    buffer_load_dwordx4 v[252:255], v15, s[8:11], s62 offen sc1
    s_add_u32 s6, s6, 2048
    s_cmp_eq_u32 s6, 57344
    s_cselect_b32 s6, 0, s6
    v_mfma_f32_32x32x16_bf16 v[32:47], v[176:179], v[212:215], v[32:47]
    ds_read_b64_tr_b16 v[128:129], v13 offset:36864
    ds_read_b64_tr_b16 v[130:131], v13 offset:37888
    ds_read_b64_tr_b16 v[132:133], v13 offset:37120
    ds_read_b64_tr_b16 v[134:135], v13 offset:38144
    v_mfma_f32_32x32x16_bf16 v[48:63], v[180:183], v[208:211], v[48:63]
    v_mfma_f32_32x32x16_bf16 v[64:79], v[180:183], v[212:215], v[64:79]
    s_waitcnt lgkmcnt(0)
    s_mul_i32 s32, s28, 100352
    s_lshl_b32 s33, s5, 7
    s_add_u32 s32, s32, s33
    s_add_u32 s32, s32, 25088
    s_add_u32 s33, s32, 7168
    s_add_u32 m0, s70, 36864
    s_nop 0
    buffer_load_dwordx4 v11, s[20:23], s32 offen lds
    s_add_u32 m0, s70, 37888
    s_nop 0
    buffer_load_dwordx4 v8, s[20:23], s33 offen lds
    s_waitcnt vmcnt(18)
    v_mfma_f32_32x32x16_bf16 v[16:31], v[184:187], v[216:219], v[16:31]
    s_add_u32 s62, s63, s6
    buffer_load_dwordx4 v[208:211], v14, s[8:11], s62 offen sc1
    buffer_load_dwordx4 v[212:215], v15, s[8:11], s62 offen sc1
    s_add_u32 s6, s6, 2048
    s_cmp_eq_u32 s6, 57344
    s_cselect_b32 s6, 0, s6
    v_mfma_f32_32x32x16_bf16 v[32:47], v[184:187], v[220:223], v[32:47]
    ds_read_b64_tr_b16 v[136:137], v13 offset:38912
    ds_read_b64_tr_b16 v[138:139], v13 offset:39936
    ds_read_b64_tr_b16 v[140:141], v13 offset:39168
    ds_read_b64_tr_b16 v[142:143], v13 offset:40192
    v_mfma_f32_32x32x16_bf16 v[48:63], v[188:191], v[216:219], v[48:63]
    v_mfma_f32_32x32x16_bf16 v[64:79], v[188:191], v[220:223], v[64:79]
    s_waitcnt lgkmcnt(0)
    s_mul_i32 s32, s28, 100352
    s_lshl_b32 s33, s5, 7
    s_add_u32 s32, s32, s33
    s_add_u32 s32, s32, 37632
    s_add_u32 s33, s32, 7168
    s_add_u32 m0, s70, 38912
    s_nop 0
    buffer_load_dwordx4 v11, s[20:23], s32 offen lds
    s_add_u32 m0, s70, 39936
    s_nop 0
    buffer_load_dwordx4 v8, s[20:23], s33 offen lds
    s_waitcnt vmcnt(18)
    v_mfma_f32_32x32x16_bf16 v[16:31], v[192:195], v[224:227], v[16:31]
    s_add_u32 s62, s63, s6
    buffer_load_dwordx4 v[216:219], v14, s[8:11], s62 offen sc1
    buffer_load_dwordx4 v[220:223], v15, s[8:11], s62 offen sc1
    s_add_u32 s6, s6, 2048
    s_cmp_eq_u32 s6, 57344
    s_cselect_b32 s6, 0, s6
    v_mfma_f32_32x32x16_bf16 v[32:47], v[192:195], v[228:231], v[32:47]
    ds_read_b64_tr_b16 v[144:145], v13 offset:0
    ds_read_b64_tr_b16 v[146:147], v13 offset:1024
    ds_read_b64_tr_b16 v[148:149], v13 offset:256
    ds_read_b64_tr_b16 v[150:151], v13 offset:1280
    v_mfma_f32_32x32x16_bf16 v[48:63], v[196:199], v[224:227], v[48:63]
    v_mfma_f32_32x32x16_bf16 v[64:79], v[196:199], v[228:231], v[64:79]
    s_waitcnt lgkmcnt(0)
    s_mul_i32 s32, s28, 100352
    s_lshl_b32 s33, s5, 7
    s_add_u32 s32, s32, s33
    s_add_u32 s32, s32, 50176
    s_add_u32 s33, s32, 7168
    s_add_u32 m0, s70, 0
    s_nop 0
    buffer_load_dwordx4 v11, s[20:23], s32 offen lds
    s_add_u32 m0, s70, 1024
    s_nop 0
    buffer_load_dwordx4 v8, s[20:23], s33 offen lds
    s_waitcnt vmcnt(18)
    v_mfma_f32_32x32x16_bf16 v[16:31], v[200:203], v[232:235], v[16:31]
    s_add_u32 s62, s63, s6
    buffer_load_dwordx4 v[224:227], v14, s[8:11], s62 offen sc1
    buffer_load_dwordx4 v[228:231], v15, s[8:11], s62 offen sc1
    s_add_u32 s6, s6, 2048
    s_cmp_eq_u32 s6, 57344
    s_cselect_b32 s6, 0, s6
    v_mfma_f32_32x32x16_bf16 v[32:47], v[200:203], v[236:239], v[32:47]
    ds_read_b64_tr_b16 v[152:153], v13 offset:2048
    ds_read_b64_tr_b16 v[154:155], v13 offset:3072
    ds_read_b64_tr_b16 v[156:157], v13 offset:2304
    ds_read_b64_tr_b16 v[158:159], v13 offset:3328
    v_mfma_f32_32x32x16_bf16 v[48:63], v[204:207], v[232:235], v[48:63]
    v_mfma_f32_32x32x16_bf16 v[64:79], v[204:207], v[236:239], v[64:79]
    s_waitcnt lgkmcnt(0)
    s_mul_i32 s32, s28, 100352
    s_lshl_b32 s33, s5, 7
    s_add_u32 s32, s32, s33
    s_add_u32 s32, s32, 62720
    s_add_u32 s33, s32, 7168
    s_add_u32 m0, s70, 2048
    s_nop 0
    buffer_load_dwordx4 v11, s[20:23], s32 offen lds
    s_add_u32 m0, s70, 3072
    s_nop 0
    buffer_load_dwordx4 v8, s[20:23], s33 offen lds
    s_waitcnt vmcnt(18)
    v_mfma_f32_32x32x16_bf16 v[16:31], v[80:83], v[240:243], v[16:31]
    s_add_u32 s62, s63, s6
    buffer_load_dwordx4 v[232:235], v14, s[8:11], s62 offen sc1
    buffer_load_dwordx4 v[236:239], v15, s[8:11], s62 offen sc1
    s_add_u32 s6, s6, 2048
    s_cmp_eq_u32 s6, 57344
    s_cselect_b32 s6, 0, s6
    v_mfma_f32_32x32x16_bf16 v[32:47], v[80:83], v[244:247], v[32:47]
    ds_read_b64_tr_b16 v[160:161], v13 offset:4096
    ds_read_b64_tr_b16 v[162:163], v13 offset:5120
    ds_read_b64_tr_b16 v[164:165], v13 offset:4352
    ds_read_b64_tr_b16 v[166:167], v13 offset:5376
    v_mfma_f32_32x32x16_bf16 v[48:63], v[84:87], v[240:243], v[48:63]
    v_mfma_f32_32x32x16_bf16 v[64:79], v[84:87], v[244:247], v[64:79]
    s_waitcnt lgkmcnt(0)
    s_mul_i32 s32, s28, 100352
    s_lshl_b32 s33, s5, 7
    s_add_u32 s32, s32, s33
    s_add_u32 s32, s32, 75264
    s_add_u32 s33, s32, 7168
    s_add_u32 m0, s70, 4096
    s_nop 0
    buffer_load_dwordx4 v11, s[20:23], s32 offen lds
    s_add_u32 m0, s70, 5120
    s_nop 0
    buffer_load_dwordx4 v8, s[20:23], s33 offen lds
    s_waitcnt vmcnt(18)
    v_mfma_f32_32x32x16_bf16 v[16:31], v[88:91], v[248:251], v[16:31]
    s_add_u32 s62, s63, s6
    buffer_load_dwordx4 v[240:243], v14, s[8:11], s62 offen sc1
    buffer_load_dwordx4 v[244:247], v15, s[8:11], s62 offen sc1
    s_add_u32 s6, s6, 2048
    s_cmp_eq_u32 s6, 57344
    s_cselect_b32 s6, 0, s6
    v_mfma_f32_32x32x16_bf16 v[32:47], v[88:91], v[252:255], v[32:47]
    ds_read_b64_tr_b16 v[168:169], v13 offset:6144
    ds_read_b64_tr_b16 v[170:171], v13 offset:7168
    ds_read_b64_tr_b16 v[172:173], v13 offset:6400
    ds_read_b64_tr_b16 v[174:175], v13 offset:7424
    v_mfma_f32_32x32x16_bf16 v[48:63], v[92:95], v[248:251], v[48:63]
    v_mfma_f32_32x32x16_bf16 v[64:79], v[92:95], v[252:255], v[64:79]
    s_waitcnt lgkmcnt(0)
    s_mul_i32 s32, s28, 100352
    s_lshl_b32 s33, s5, 7
    s_add_u32 s32, s32, s33
    s_add_u32 s32, s32, 87808
    s_add_u32 s33, s32, 7168
    s_add_u32 m0, s70, 6144
    s_nop 0
    buffer_load_dwordx4 v11, s[20:23], s32 offen lds
    s_add_u32 m0, s70, 7168
    s_nop 0
    buffer_load_dwordx4 v8, s[20:23], s33 offen lds
    s_waitcnt vmcnt(18)
    v_mfma_f32_32x32x16_bf16 v[16:31], v[96:99], v[208:211], v[16:31]
    s_add_u32 s62, s63, s6
    buffer_load_dwordx4 v[248:251], v14, s[8:11], s62 offen sc1
    buffer_load_dwordx4 v[252:255], v15, s[8:11], s62 offen sc1
    s_add_u32 s6, s6, 2048
    s_cmp_eq_u32 s6, 57344
    s_cselect_b32 s6, 0, s6
    v_mfma_f32_32x32x16_bf16 v[32:47], v[96:99], v[212:215], v[32:47]
    ds_read_b64_tr_b16 v[176:177], v13 offset:32768
    ds_read_b64_tr_b16 v[178:179], v13 offset:33792
    ds_read_b64_tr_b16 v[180:181], v13 offset:33024
    ds_read_b64_tr_b16 v[182:183], v13 offset:34048
    v_mfma_f32_32x32x16_bf16 v[48:63], v[100:103], v[208:211], v[48:63]
    v_mfma_f32_32x32x16_bf16 v[64:79], v[100:103], v[212:215], v[64:79]
    s_waitcnt lgkmcnt(0)
    s_waitcnt vmcnt(16)
    v_mfma_f32_32x32x16_bf16 v[16:31], v[104:107], v[216:219], v[16:31]
    s_add_u32 s62, s63, s6
    buffer_load_dwordx4 v[208:211], v14, s[8:11], s62 offen sc1
    buffer_load_dwordx4 v[212:215], v15, s[8:11], s62 offen sc1
    s_add_u32 s6, s6, 2048
    s_cmp_eq_u32 s6, 57344
    s_cselect_b32 s6, 0, s6
    v_mfma_f32_32x32x16_bf16 v[32:47], v[104:107], v[220:223], v[32:47]
    ds_read_b64_tr_b16 v[184:185], v13 offset:34816
    ds_read_b64_tr_b16 v[186:187], v13 offset:35840
    ds_read_b64_tr_b16 v[188:189], v13 offset:35072
    ds_read_b64_tr_b16 v[190:191], v13 offset:36096
    v_mfma_f32_32x32x16_bf16 v[48:63], v[108:111], v[216:219], v[48:63]
    v_mfma_f32_32x32x16_bf16 v[64:79], v[108:111], v[220:223], v[64:79]
    s_waitcnt lgkmcnt(0)
    s_waitcnt vmcnt(14)
    v_mfma_f32_32x32x16_bf16 v[16:31], v[112:115], v[224:227], v[16:31]
    s_add_u32 s62, s63, s6
    buffer_load_dwordx4 v[216:219], v14, s[8:11], s62 offen sc1
    buffer_load_dwordx4 v[220:223], v15, s[8:11], s62 offen sc1
    s_add_u32 s6, s6, 2048
    s_cmp_eq_u32 s6, 57344
    s_cselect_b32 s6, 0, s6
    v_mfma_f32_32x32x16_bf16 v[32:47], v[112:115], v[228:231], v[32:47]
    ds_read_b64_tr_b16 v[192:193], v13 offset:36864
    ds_read_b64_tr_b16 v[194:195], v13 offset:37888
    ds_read_b64_tr_b16 v[196:197], v13 offset:37120
    ds_read_b64_tr_b16 v[198:199], v13 offset:38144
    v_mfma_f32_32x32x16_bf16 v[48:63], v[116:119], v[224:227], v[48:63]
    v_mfma_f32_32x32x16_bf16 v[64:79], v[116:119], v[228:231], v[64:79]
    s_waitcnt lgkmcnt(0)
    s_waitcnt vmcnt(12)
    v_mfma_f32_32x32x16_bf16 v[16:31], v[120:123], v[232:235], v[16:31]
    s_add_u32 s62, s63, s6
    buffer_load_dwordx4 v[224:227], v14, s[8:11], s62 offen sc1
    buffer_load_dwordx4 v[228:231], v15, s[8:11], s62 offen sc1
    s_add_u32 s6, s6, 2048
    s_cmp_eq_u32 s6, 57344
    s_cselect_b32 s6, 0, s6
    v_mfma_f32_32x32x16_bf16 v[32:47], v[120:123], v[236:239], v[32:47]
    ds_read_b64_tr_b16 v[200:201], v13 offset:38912
    ds_read_b64_tr_b16 v[202:203], v13 offset:39936
    ds_read_b64_tr_b16 v[204:205], v13 offset:39168
    ds_read_b64_tr_b16 v[206:207], v13 offset:40192
    v_mfma_f32_32x32x16_bf16 v[48:63], v[124:127], v[232:235], v[48:63]
    v_mfma_f32_32x32x16_bf16 v[64:79], v[124:127], v[236:239], v[64:79]
    s_waitcnt lgkmcnt(0)
    s_waitcnt vmcnt(10)
    v_mfma_f32_32x32x16_bf16 v[16:31], v[128:131], v[240:243], v[16:31]
    s_add_u32 s62, s63, s6
    buffer_load_dwordx4 v[232:235], v14, s[8:11], s62 offen sc1
    buffer_load_dwordx4 v[236:239], v15, s[8:11], s62 offen sc1
    s_add_u32 s6, s6, 2048
    s_cmp_eq_u32 s6, 57344
    s_cselect_b32 s6, 0, s6
    v_mfma_f32_32x32x16_bf16 v[32:47], v[128:131], v[244:247], v[32:47]
    ds_read_b64_tr_b16 v[80:81], v13 offset:0
    ds_read_b64_tr_b16 v[82:83], v13 offset:1024
    ds_read_b64_tr_b16 v[84:85], v13 offset:256
    ds_read_b64_tr_b16 v[86:87], v13 offset:1280
    v_mfma_f32_32x32x16_bf16 v[48:63], v[132:135], v[240:243], v[48:63]
    v_mfma_f32_32x32x16_bf16 v[64:79], v[132:135], v[244:247], v[64:79]
    s_waitcnt lgkmcnt(0)
    s_waitcnt vmcnt(8)
    v_mfma_f32_32x32x16_bf16 v[16:31], v[136:139], v[248:251], v[16:31]
    v_mfma_f32_32x32x16_bf16 v[32:47], v[136:139], v[252:255], v[32:47]
    ds_read_b64_tr_b16 v[88:89], v13 offset:2048
    ds_read_b64_tr_b16 v[90:91], v13 offset:3072
    ds_read_b64_tr_b16 v[92:93], v13 offset:2304
    ds_read_b64_tr_b16 v[94:95], v13 offset:3328
    v_mfma_f32_32x32x16_bf16 v[48:63], v[140:143], v[248:251], v[48:63]
    v_mfma_f32_32x32x16_bf16 v[64:79], v[140:143], v[252:255], v[64:79]
    s_waitcnt lgkmcnt(0)
    s_waitcnt vmcnt(6)
    v_mfma_f32_32x32x16_bf16 v[16:31], v[144:147], v[208:211], v[16:31]
    v_mfma_f32_32x32x16_bf16 v[32:47], v[144:147], v[212:215], v[32:47]
    ds_read_b64_tr_b16 v[96:97], v13 offset:4096
    ds_read_b64_tr_b16 v[98:99], v13 offset:5120
    ds_read_b64_tr_b16 v[100:101], v13 offset:4352
    ds_read_b64_tr_b16 v[102:103], v13 offset:5376
    v_mfma_f32_32x32x16_bf16 v[48:63], v[148:151], v[208:211], v[48:63]
    v_mfma_f32_32x32x16_bf16 v[64:79], v[148:151], v[212:215], v[64:79]
    s_waitcnt lgkmcnt(0)
    s_waitcnt vmcnt(4)
    v_mfma_f32_32x32x16_bf16 v[16:31], v[152:155], v[216:219], v[16:31]
    v_mfma_f32_32x32x16_bf16 v[32:47], v[152:155], v[220:223], v[32:47]
    ds_read_b64_tr_b16 v[104:105], v13 offset:6144
    ds_read_b64_tr_b16 v[106:107], v13 offset:7168
    ds_read_b64_tr_b16 v[108:109], v13 offset:6400
    ds_read_b64_tr_b16 v[110:111], v13 offset:7424
    v_mfma_f32_32x32x16_bf16 v[48:63], v[156:159], v[216:219], v[48:63]
    v_mfma_f32_32x32x16_bf16 v[64:79], v[156:159], v[220:223], v[64:79]
    s_waitcnt lgkmcnt(0)
    s_waitcnt vmcnt(2)
    v_mfma_f32_32x32x16_bf16 v[16:31], v[160:163], v[224:227], v[16:31]
    v_mfma_f32_32x32x16_bf16 v[32:47], v[160:163], v[228:231], v[32:47]
    v_mfma_f32_32x32x16_bf16 v[48:63], v[164:167], v[224:227], v[48:63]
    v_mfma_f32_32x32x16_bf16 v[64:79], v[164:167], v[228:231], v[64:79]
    s_waitcnt vmcnt(0)
    v_mfma_f32_32x32x16_bf16 v[16:31], v[168:171], v[232:235], v[16:31]
    v_mfma_f32_32x32x16_bf16 v[32:47], v[168:171], v[236:239], v[32:47]
    v_mfma_f32_32x32x16_bf16 v[48:63], v[172:175], v[232:235], v[48:63]
    v_mfma_f32_32x32x16_bf16 v[64:79], v[172:175], v[236:239], v[64:79]
    v_mov_b32 v13, 1
    s_mov_b64 exec, 1
    ds_add_u32 v12, v13 offset:8
    s_mov_b64 exec, -1
    v_and_b32 v179, 0xffff, v179
    v_and_b32 v183, 0xffff, v183
    v_and_b32 v187, 0xffff, v187
    v_and_b32 v191, 0xffff, v191
    v_and_b32 v195, 0xffff, v195
    v_and_b32 v199, 0xffff, v199
    v_and_b32 v203, 0xffff, v203
    v_and_b32 v207, 0xffff, v207
    v_and_b32 v83, 0xffff, v83
    v_and_b32 v87, 0xffff, v87
    v_and_b32 v91, 0xffff, v91
    v_and_b32 v95, 0xffff, v95
    v_and_b32 v99, 0xffff, v99
    v_and_b32 v103, 0xffff, v103
    v_and_b32 v107, 0xffff, v107
    v_and_b32 v111, 0xffff, v111
    s_lshl_b32 s32, s28, 10
    s_add_u32 s61, s61, s32
    s_add_u32 s61, s61, 0x10000
    s_mul_i32 s32, s28, 20
    s_sub_u32 s32, 112, s32
    s_lshl_b32 s32, s32, 11
    s_add_u32 s62, s63, s32
    s_mov_b32 s16, s52
    s_mov_b32 s17, s53
    s_mov_b32 s18, 0x1c0000
    s_mov_b32 s19, 0x00020000
    s_xor_b32 s32, s28, 0
    s_cmp_ge_u32 s32, 2
    s_mul_i32 s32, s32, 12288
    s_cselect_b32 s33, 49152, 0
    s_add_u32 s32, s32, s33
    s_add_u32 s32, s32, 49152
    v_add_u32 v4, s32, v2
    s_xor_b32 s32, s28, 1
    s_cmp_ge_u32 s32, 2
    s_mul_i32 s32, s32, 12288
    s_cselect_b32 s33, 49152, 0
    s_add_u32 s32, s32, s33
    s_add_u32 s32, s32, 49152
    v_add_u32 v5, s32, v2
    s_xor_b32 s32, s28, 2
    s_cmp_ge_u32 s32, 2
    s_mul_i32 s32, s32, 12288
    s_cselect_b32 s33, 49152, 0
    s_add_u32 s32, s32, s33
    s_add_u32 s32, s32, 49152
    v_add_u32 v6, s32, v2
    s_xor_b32 s32, s28, 3
    s_cmp_ge_u32 s32, 2
    s_mul_i32 s32, s32, 12288
    s_cselect_b32 s33, 49152, 0
    s_add_u32 s32, s32, s33
    s_add_u32 s32, s32, 49152
    v_add_u32 v7, s32, v2
    s_setprio 3
    s_mov_b32 s56, 1048576
L_BL2:
    ds_read_b32 v13, v12 offset:0
    s_sub_u32 s56, s56, 1
    s_cbranch_scc1 L_BLX2
    s_waitcnt lgkmcnt(0)
    v_readfirstlane_b32 s32, v13
    s_cmp_ge_u32 s32, 8
    s_cbranch_scc1 L_BLX2
    s_sleep 2
    s_branch L_BL2
L_BLX2:
    s_setprio 0
    v_and_b32 v9, 7, v1
    v_lshrrev_b32 v10, 1, v9
    v_and_b32 v9, 1, v9
    v_lshlrev_b32 v9, 10, v9
    v_lshl_add_u32 v9, v10, 12, v9
    s_mov_b32 s33, 0x10000
    s_mov_b32 s56, 131072
L_SNa:
    buffer_load_dword v10, v9, s[8:11], s62 offen offset:3068 sc1
    s_sub_u32 s56, s56, 1
    s_cbranch_scc1 L_SNTa
    s_waitcnt vmcnt(0)
    v_cmp_gt_u32 vcc, s33, v10
    s_cbranch_vccz L_SNXa
    s_sleep 1
    s_branch L_SNa
L_SNTa:
    s_mov_b32 s56, 0
L_SNXa:
    s_mov_b32 s56, 131072
    s_mov_b32 s33, 0x10000
    s_add_u32 s32, s62, 0
    buffer_load_dwordx4 v[112:115], v14, s[8:11], s32 offen sc1
    buffer_load_dwordx4 v[116:119], v15, s[8:11], s32 offen sc1
    s_add_u32 s32, s62, 2048
    buffer_load_dwordx4 v[120:123], v14, s[8:11], s32 offen sc1
    buffer_load_dwordx4 v[124:127], v15, s[8:11], s32 offen sc1
    s_add_u32 s32, s62, 4096
    buffer_load_dwordx4 v[128:131], v14, s[8:11], s32 offen sc1
    buffer_load_dwordx4 v[132:135], v15, s[8:11], s32 offen sc1
    s_add_u32 s32, s62, 6144
    buffer_load_dwordx4 v[136:139], v14, s[8:11], s32 offen sc1
    buffer_load_dwordx4 v[140:143], v15, s[8:11], s32 offen sc1
    s_add_u32 s32, s62, 8192
    buffer_load_dwordx4 v[144:147], v14, s[8:11], s32 offen sc1
    buffer_load_dwordx4 v[148:151], v15, s[8:11], s32 offen sc1
    s_add_u32 s32, s62, 10240
    buffer_load_dwordx4 v[152:155], v14, s[8:11], s32 offen sc1
    buffer_load_dwordx4 v[156:159], v15, s[8:11], s32 offen sc1
    s_add_u32 s32, s62, 12288
    buffer_load_dwordx4 v[160:163], v14, s[8:11], s32 offen sc1
    buffer_load_dwordx4 v[164:167], v15, s[8:11], s32 offen sc1
    s_add_u32 s32, s62, 14336
    buffer_load_dwordx4 v[168:171], v14, s[8:11], s32 offen sc1
    buffer_load_dwordx4 v[172:175], v15, s[8:11], s32 offen sc1
L_OW0:
    s_waitcnt vmcnt(12)
    v_min3_u32 v10, v115, v119, v123
    v_min_u32 v10, v10, v127
    v_cmp_gt_u32 vcc, s33, v10
    s_cbranch_vccnz L_OR0
L_OK0:
    v_mfma_f32_32x32x16_bf16 v[16:31], v[176:179], v[112:115], v[16:31]
    v_mfma_f32_32x32x16_bf16 v[32:47], v[176:179], v[116:119], v[32:47]
    v_mfma_f32_32x32x16_bf16 v[48:63], v[180:183], v[112:115], v[48:63]
    v_mfma_f32_32x32x16_bf16 v[64:79], v[180:183], v[116:119], v[64:79]
    v_mfma_f32_32x32x16_bf16 v[16:31], v[184:187], v[120:123], v[16:31]
    v_mfma_f32_32x32x16_bf16 v[32:47], v[184:187], v[124:127], v[32:47]
    v_mfma_f32_32x32x16_bf16 v[48:63], v[188:191], v[120:123], v[48:63]
    v_mfma_f32_32x32x16_bf16 v[64:79], v[188:191], v[124:127], v[64:79]
L_OW1:
    s_waitcnt vmcnt(8)
    v_min3_u32 v10, v131, v135, v139
    v_min_u32 v10, v10, v143
    v_cmp_gt_u32 vcc, s33, v10
    s_cbranch_vccnz L_OR1
L_OK1:
    v_mfma_f32_32x32x16_bf16 v[16:31], v[192:195], v[128:131], v[16:31]
    v_mfma_f32_32x32x16_bf16 v[32:47], v[192:195], v[132:135], v[32:47]
    v_mfma_f32_32x32x16_bf16 v[48:63], v[196:199], v[128:131], v[48:63]
    v_mfma_f32_32x32x16_bf16 v[64:79], v[196:199], v[132:135], v[64:79]
    v_mfma_f32_32x32x16_bf16 v[16:31], v[200:203], v[136:139], v[16:31]
    v_mfma_f32_32x32x16_bf16 v[32:47], v[200:203], v[140:143], v[32:47]
    v_mfma_f32_32x32x16_bf16 v[48:63], v[204:207], v[136:139], v[48:63]
    v_mfma_f32_32x32x16_bf16 v[64:79], v[204:207], v[140:143], v[64:79]
L_OW2:
    s_waitcnt vmcnt(4)
    v_min3_u32 v10, v147, v151, v155
    v_min_u32 v10, v10, v159
    v_cmp_gt_u32 vcc, s33, v10
    s_cbranch_vccnz L_OR2
L_OK2:
    v_mfma_f32_32x32x16_bf16 v[16:31], v[80:83], v[144:147], v[16:31]
    v_mfma_f32_32x32x16_bf16 v[32:47], v[80:83], v[148:151], v[32:47]
    v_mfma_f32_32x32x16_bf16 v[48:63], v[84:87], v[144:147], v[48:63]
    v_mfma_f32_32x32x16_bf16 v[64:79], v[84:87], v[148:151], v[64:79]
    v_mfma_f32_32x32x16_bf16 v[16:31], v[88:91], v[152:155], v[16:31]
    v_mfma_f32_32x32x16_bf16 v[32:47], v[88:91], v[156:159], v[32:47]
    v_mfma_f32_32x32x16_bf16 v[48:63], v[92:95], v[152:155], v[48:63]
    v_mfma_f32_32x32x16_bf16 v[64:79], v[92:95], v[156:159], v[64:79]
L_OW3:
    s_waitcnt vmcnt(0)
    v_min3_u32 v10, v163, v167, v171
    v_min_u32 v10, v10, v175
    v_cmp_gt_u32 vcc, s33, v10
    s_cbranch_vccnz L_OR3
L_OK3:
    ds_read_b32 v13, v12 offset:8
    v_mfma_f32_32x32x16_bf16 v[16:31], v[96:99], v[160:163], v[16:31]
    v_mfma_f32_32x32x16_bf16 v[32:47], v[96:99], v[164:167], v[32:47]
    v_mfma_f32_32x32x16_bf16 v[48:63], v[100:103], v[160:163], v[48:63]
    v_mfma_f32_32x32x16_bf16 v[64:79], v[100:103], v[164:167], v[64:79]
    v_mfma_f32_32x32x16_bf16 v[16:31], v[104:107], v[168:171], v[16:31]
    v_mfma_f32_32x32x16_bf16 v[32:47], v[104:107], v[172:175], v[32:47]
    v_mfma_f32_32x32x16_bf16 v[48:63], v[108:111], v[168:171], v[48:63]
    v_mfma_f32_32x32x16_bf16 v[64:79], v[108:111], v[172:175], v[64:79]
    s_waitcnt lgkmcnt(0)
    v_readfirstlane_b32 s32, v13
    s_cmp_ge_u32 s32, 4
    s_cbranch_scc1 L_BD
    s_setprio 3
    s_mov_b32 s56, 1048576
L_BL3:
    ds_read_b32 v13, v12 offset:8
    s_sub_u32 s56, s56, 1
    s_cbranch_scc1 L_BLX3
    s_waitcnt lgkmcnt(0)
    v_readfirstlane_b32 s32, v13
    s_cmp_ge_u32 s32, 4
    s_cbranch_scc1 L_BLX3
    s_branch L_BL3
L_BLX3:
    s_setprio 0
L_BD:
    s_nop 5
    ds_write_b128 v5, v[32:35] offset:0
    ds_write_b128 v5, v[36:39] offset:1024
    ds_write_b128 v5, v[40:43] offset:2048
    ds_write_b128 v5, v[44:47] offset:3072
    ds_write_b128 v6, v[48:51] offset:4096
    ds_write_b128 v6, v[52:55] offset:5120
    ds_write_b128 v6, v[56:59] offset:6144
    ds_write_b128 v6, v[60:63] offset:7168
    ds_write_b128 v7, v[64:67] offset:8192
    ds_write_b128 v7, v[68:71] offset:9216
    ds_write_b128 v7, v[72:75] offset:10240
    ds_write_b128 v7, v[76:79] offset:11264
    s_waitcnt lgkmcnt(0)
    s_barrier
    ds_read_b128 v[32:35], v4 offset:0
    ds_read_b128 v[36:39], v4 offset:1024
    ds_read_b128 v[40:43], v4 offset:2048
    ds_read_b128 v[44:47], v4 offset:3072
    ds_read_b128 v[48:51], v4 offset:4096
    ds_read_b128 v[52:55], v4 offset:5120
    ds_read_b128 v[56:59], v4 offset:6144
    ds_read_b128 v[60:63], v4 offset:7168
    ds_read_b128 v[64:67], v4 offset:8192
    ds_read_b128 v[68:71], v4 offset:9216
    ds_read_b128 v[72:75], v4 offset:10240
    ds_read_b128 v[76:79], v4 offset:11264
    s_waitcnt lgkmcnt(8)
    v_add_f32 v16, v16, v32
    v_add_f32 v17, v17, v33
    v_add_f32 v18, v18, v34
    v_add_f32 v19, v19, v35
    v_add_f32 v20, v20, v36
    v_add_f32 v21, v21, v37
    v_add_f32 v22, v22, v38
    v_add_f32 v23, v23, v39
    v_add_f32 v24, v24, v40
    v_add_f32 v25, v25, v41
    v_add_f32 v26, v26, v42
    v_add_f32 v27, v27, v43
    v_add_f32 v28, v28, v44
    v_add_f32 v29, v29, v45
    v_add_f32 v30, v30, v46
    v_add_f32 v31, v31, v47
    s_waitcnt lgkmcnt(0)
    v_add_f32 v48, v48, v64
    v_add_f32 v49, v49, v65
    v_add_f32 v50, v50, v66
    v_add_f32 v51, v51, v67
    v_add_f32 v52, v52, v68
    v_add_f32 v53, v53, v69
    v_add_f32 v54, v54, v70
    v_add_f32 v55, v55, v71
    v_add_f32 v56, v56, v72
    v_add_f32 v57, v57, v73
    v_add_f32 v58, v58, v74
    v_add_f32 v59, v59, v75
    v_add_f32 v60, v60, v76
    v_add_f32 v61, v61, v77
    v_add_f32 v62, v62, v78
    v_add_f32 v63, v63, v79
    v_add_f32 v16, v16, v48
    v_add_f32 v17, v17, v49
    v_add_f32 v18, v18, v50
    v_add_f32 v19, v19, v51
    v_add_f32 v20, v20, v52
    v_add_f32 v21, v21, v53
    v_add_f32 v22, v22, v54
    v_add_f32 v23, v23, v55
    v_add_f32 v24, v24, v56
    v_add_f32 v25, v25, v57
    v_add_f32 v26, v26, v58
    v_add_f32 v27, v27, v59
    v_add_f32 v28, v28, v60
    v_add_f32 v29, v29, v61
    v_add_f32 v30, v30, v62
    v_add_f32 v31, v31, v63
    v_cvt_pk_bf16_f32 v80, v16, v17
    v_cvt_pk_bf16_f32 v81, v18, v19
    v_cvt_pk_bf16_f32 v82, v20, v21
    v_cvt_pk_bf16_f32 v83, v22, v23
    v_cvt_pk_bf16_f32 v84, v24, v25
    v_cvt_pk_bf16_f32 v85, v26, v27
    v_cvt_pk_bf16_f32 v86, v28, v29
    v_cvt_pk_bf16_f32 v87, v30, v31
    v_permlane32_swap_b32 v80, v82
    v_permlane32_swap_b32 v81, v83
    v_permlane32_swap_b32 v84, v86
    v_permlane32_swap_b32 v85, v87
    buffer_store_dwordx4 v[80:83], v0, s[16:19], s60 offen offset:0
    buffer_store_dwordx4 v[84:87], v0, s[16:19], s60 offen offset:32
    s_endpgm
L_OR0:
    s_sub_u32 s56, s56, 1
    s_cselect_b32 s56, 0, s56
    s_cbranch_scc1 L_OK0
    s_waitcnt vmcnt(0)
    s_add_u32 s32, s62, 0
    buffer_load_dwordx4 v[112:115], v14, s[8:11], s32 offen sc1
    buffer_load_dwordx4 v[116:119], v15, s[8:11], s32 offen sc1
    s_add_u32 s32, s62, 2048
    buffer_load_dwordx4 v[120:123], v14, s[8:11], s32 offen sc1
    buffer_load_dwordx4 v[124:127], v15, s[8:11], s32 offen sc1
    s_add_u32 s32, s62, 4096
    buffer_load_dwordx4 v[128:131], v14, s[8:11], s32 offen sc1
    buffer_load_dwordx4 v[132:135], v15, s[8:11], s32 offen sc1
    s_add_u32 s32, s62, 6144
    buffer_load_dwordx4 v[136:139], v14, s[8:11], s32 offen sc1
    buffer_load_dwordx4 v[140:143], v15, s[8:11], s32 offen sc1
    s_add_u32 s32, s62, 8192
    buffer_load_dwordx4 v[144:147], v14, s[8:11], s32 offen sc1
    buffer_load_dwordx4 v[148:151], v15, s[8:11], s32 offen sc1
    s_add_u32 s32, s62, 10240
    buffer_load_dwordx4 v[152:155], v14, s[8:11], s32 offen sc1
    buffer_load_dwordx4 v[156:159], v15, s[8:11], s32 offen sc1
    s_add_u32 s32, s62, 12288
    buffer_load_dwordx4 v[160:163], v14, s[8:11], s32 offen sc1
    buffer_load_dwordx4 v[164:167], v15, s[8:11], s32 offen sc1
    s_add_u32 s32, s62, 14336
    buffer_load_dwordx4 v[168:171], v14, s[8:11], s32 offen sc1
    buffer_load_dwordx4 v[172:175], v15, s[8:11], s32 offen sc1
    s_branch L_OW0
L_OR1:
    s_sub_u32 s56, s56, 1
    s_cselect_b32 s56, 0, s56
    s_cbranch_scc1 L_OK1
    s_waitcnt vmcnt(0)
    s_add_u32 s32, s62, 4096
    buffer_load_dwordx4 v[128:131], v14, s[8:11], s32 offen sc1
    buffer_load_dwordx4 v[132:135], v15, s[8:11], s32 offen sc1
    s_add_u32 s32, s62, 6144
    buffer_load_dwordx4 v[136:139], v14, s[8:11], s32 offen sc1
    buffer_load_dwordx4 v[140:143], v15, s[8:11], s32 offen sc1
    s_add_u32 s32, s62, 8192
    buffer_load_dwordx4 v[144:147], v14, s[8:11], s32 offen sc1
    buffer_load_dwordx4 v[148:151], v15, s[8:11], s32 offen sc1
    s_add_u32 s32, s62, 10240
    buffer_load_dwordx4 v[152:155], v14, s[8:11], s32 offen sc1
    buffer_load_dwordx4 v[156:159], v15, s[8:11], s32 offen sc1
    s_add_u32 s32, s62, 12288
    buffer_load_dwordx4 v[160:163], v14, s[8:11], s32 offen sc1
    buffer_load_dwordx4 v[164:167], v15, s[8:11], s32 offen sc1
    s_add_u32 s32, s62, 14336
    buffer_load_dwordx4 v[168:171], v14, s[8:11], s32 offen sc1
    buffer_load_dwordx4 v[172:175], v15, s[8:11], s32 offen sc1
    s_branch L_OW1
L_OR2:
    s_sub_u32 s56, s56, 1
    s_cselect_b32 s56, 0, s56
    s_cbranch_scc1 L_OK2
    s_waitcnt vmcnt(0)
    s_add_u32 s32, s62, 8192
    buffer_load_dwordx4 v[144:147], v14, s[8:11], s32 offen sc1
    buffer_load_dwordx4 v[148:151], v15, s[8:11], s32 offen sc1
    s_add_u32 s32, s62, 10240
    buffer_load_dwordx4 v[152:155], v14, s[8:11], s32 offen sc1
    buffer_load_dwordx4 v[156:159], v15, s[8:11], s32 offen sc1
    s_add_u32 s32, s62, 12288
    buffer_load_dwordx4 v[160:163], v14, s[8:11], s32 offen sc1
    buffer_load_dwordx4 v[164:167], v15, s[8:11], s32 offen sc1
    s_add_u32 s32, s62, 14336
    buffer_load_dwordx4 v[168:171], v14, s[8:11], s32 offen sc1
    buffer_load_dwordx4 v[172:175], v15, s[8:11], s32 offen sc1
    s_branch L_OW2
L_OR3:
    s_sub_u32 s56, s56, 1
    s_cselect_b32 s56, 0, s56
    s_cbranch_scc1 L_OK3
    s_waitcnt vmcnt(0)
    s_add_u32 s32, s62, 12288
    buffer_load_dwordx4 v[160:163], v14, s[8:11], s32 offen sc1
    buffer_load_dwordx4 v[164:167], v15, s[8:11], s32 offen sc1
    s_add_u32 s32, s62, 14336
    buffer_load_dwordx4 v[168:171], v14, s[8:11], s32 offen sc1
    buffer_load_dwordx4 v[172:175], v15, s[8:11], s32 offen sc1
    s_branch L_OW3
L_A:
    s_setprio 2
    v_lshlrev_b32 v16, 2, v1
    v_add_u32 v16, 153600, v16
    v_mov_b32 v17, 0
    ds_write_b32 v16, v17
    s_lshl_b32 s5, s29, 2
    s_add_u32 s5, s5, s28
    s_mov_b32 s62, 0x3f803f80
    v_and_b32 v16, 31, v1
    v_bfe_u32 v17, v1, 1, 3
    v_xor_b32 v17, v17, v4
    v_lshlrev_b32 v16, 7, v16
    v_lshl_add_u32 v16, v17, 4, v16
    s_lshl_b32 s32, s28, 12
    v_xor_b32 v17, 0, v16
    v_add_u32 v9, s32, v17
    v_xor_b32 v17, 32, v16
    v_add_u32 v10, s32, v17
    v_xor_b32 v17, 64, v16
    v_add_u32 v11, s32, v17
    v_xor_b32 v17, 96, v16
    v_add_u32 v12, s32, v17
    v_lshl_add_u32 v14, v4, 11, v8
    v_and_b32 v17, 48, v8
    v_cmp_eq_u32 s[38:39], 48, v17
    v_or_b32 v17, 8, v8
    s_nop 0
    v_cndmask_b32 v17, v8, v17, s[38:39]
    v_lshl_add_u32 v13, v4, 10, v17
    v_lshl_add_u32 v15, v4, 9, v17
    v_mov_b32 v200, 0
    v_mov_b32 v202, 0
    v_mov_b32 v204, 0
    v_mov_b32 v205, 0
    s_mov_b32 s19, 0
    s_mov_b32 s21, 0
    s_lshl_b32 s16, s30, 2
    s_add_u32 s16, s16, s28
    s_lshl_b32 s16, s16, 16
    s_add_u32 s16, s16, 0x200000
    s_lshl_b32 s32, s28, 13
    v_add_u32 v249, s32, v2
    v_add_u32 v251, 81920, v249
    v_add_u32 v249, 49152, v249
    s_mul_i32 s32, s28, 24576
    s_add_u32 s32, s32, 20480
    s_lshl_b32 s33, s28, 12
    s_add_u32 s33, s33, 135168
    s_cmp_ge_u32 s28, 2
    s_cselect_b32 s32, s33, s32
    v_add_u32 v250, s32, v2
    s_lshl_b32 s32, s28, 2
    s_add_u32 s32, s32, 153616
    v_mov_b32 v252, s32
    s_lshl_b32 s32, s28, 12
    v_add_u32 v248, s32, v2
    s_bitcmp1_b32 s100, 0
    s_cselect_b32 s63, s62, 0x3f80
    v_lshlrev_b32 v255, 2, v7
    v_add_u32 v255, 153600, v255
    s_lshl_b32 s32, s28, 11
    v_add_u32 v5, s32, v13
    s_lshl_b32 s32, s28, 2
    s_add_u32 s32, s32, 155648
    v_add_u32 v0, s32, v2
    s_waitcnt lgkmcnt(0)
    s_mov_b32 s8, s46
    s_mov_b32 s9, s47
    s_mov_b32 s10, 0xf00000
    s_mov_b32 s11, 0x00020000
    s_barrier
    ds_read_b64_tr_b16 v[208:209], v5 offset:16384
    ds_read_b64_tr_b16 v[210:211], v5 offset:16896
    ds_read_b64_tr_b16 v[212:213], v5 offset:16640
    ds_read_b64_tr_b16 v[214:215], v5 offset:17152
    ds_read_b128 v[24:27], v9 offset:0
    ds_read_b64_tr_b16 v[168:169], v13 offset:16384
    ds_read_b64_tr_b16 v[170:171], v13 offset:16896
    ds_read_b64_tr_b16 v[172:173], v13 offset:16640
    ds_read_b64_tr_b16 v[174:175], v13 offset:17152
    ds_read_b128 v[28:31], v10 offset:0
    ds_read_b64_tr_b16 v[176:177], v13 offset:18432
    ds_read_b64_tr_b16 v[178:179], v13 offset:18944
    ds_read_b64_tr_b16 v[180:181], v13 offset:18688
    ds_read_b64_tr_b16 v[182:183], v13 offset:19200
    ds_read_b128 v[32:35], v11 offset:0
    ds_read_b64_tr_b16 v[184:185], v13 offset:20480
    ds_read_b64_tr_b16 v[186:187], v13 offset:20992
    ds_read_b64_tr_b16 v[188:189], v13 offset:20736
    ds_read_b64_tr_b16 v[190:191], v13 offset:21248
    ds_read_b128 v[36:39], v12 offset:0
    ds_read_b64_tr_b16 v[192:193], v13 offset:22528
    ds_read_b64_tr_b16 v[194:195], v13 offset:23040
    ds_read_b64_tr_b16 v[196:197], v13 offset:22784
    ds_read_b64_tr_b16 v[198:199], v13 offset:23296
    s_waitcnt lgkmcnt(15)
    v_dot2c_f32_bf16 v204, s62, v208
    v_dot2c_f32_bf16 v205, s62, v212
    v_dot2c_f32_bf16 v204, s62, v209
    v_dot2c_f32_bf16 v205, s62, v213
    v_dot2c_f32_bf16 v204, s62, v210
    v_dot2c_f32_bf16 v205, s62, v214
    v_dot2c_f32_bf16 v204, s62, v211
    v_dot2c_f32_bf16 v205, s62, v215
    v_dot2c_f32_bf16 v200, s62, v24
    v_dot2c_f32_bf16 v202, v24, v24
    v_dot2c_f32_bf16 v200, s62, v25
    v_dot2c_f32_bf16 v202, v25, v25
    v_dot2c_f32_bf16 v200, s62, v26
    v_dot2c_f32_bf16 v202, v26, v26
    v_dot2c_f32_bf16 v200, s62, v27
    v_dot2c_f32_bf16 v202, v27, v27
    s_waitcnt lgkmcnt(10)
    v_dot2c_f32_bf16 v200, s62, v28
    v_dot2c_f32_bf16 v202, v28, v28
    v_dot2c_f32_bf16 v200, s62, v29
    v_dot2c_f32_bf16 v202, v29, v29
    v_dot2c_f32_bf16 v200, s62, v30
    v_dot2c_f32_bf16 v202, v30, v30
    v_dot2c_f32_bf16 v200, s62, v31
    v_dot2c_f32_bf16 v202, v31, v31
    s_waitcnt lgkmcnt(5)
    v_dot2c_f32_bf16 v200, s62, v32
    v_dot2c_f32_bf16 v202, v32, v32
    v_dot2c_f32_bf16 v200, s62, v33
    v_dot2c_f32_bf16 v202, v33, v33
    v_dot2c_f32_bf16 v200, s62, v34
    v_dot2c_f32_bf16 v202, v34, v34
    v_dot2c_f32_bf16 v200, s62, v35
    v_dot2c_f32_bf16 v202, v35, v35
    s_waitcnt lgkmcnt(0)
    v_dot2c_f32_bf16 v200, s62, v36
    v_dot2c_f32_bf16 v202, v36, v36
    v_dot2c_f32_bf16 v200, s62, v37
    v_dot2c_f32_bf16 v202, v37, v37
    v_dot2c_f32_bf16 v200, s62, v38
    v_dot2c_f32_bf16 v202, v38, v38
    v_dot2c_f32_bf16 v200, s62, v39
    v_dot2c_f32_bf16 v202, v39, v39
    v_mfma_f32_32x32x16_bf16 v[136:151], v[168:171], v[24:27], 0
    v_mfma_f32_32x32x16_bf16 v[152:167], v[172:175], v[24:27], 0
    v_mfma_f32_32x32x16_bf16 v[136:151], v[176:179], v[28:31], v[136:151]
    v_mfma_f32_32x32x16_bf16 v[152:167], v[180:183], v[28:31], v[152:167]
    s_barrier
    ds_read_b64_tr_b16 v[208:209], v5 offset:40960
    ds_read_b64_tr_b16 v[210:211], v5 offset:41472
    ds_read_b64_tr_b16 v[212:213], v5 offset:41216
    ds_read_b64_tr_b16 v[214:215], v5 offset:41728
    v_mfma_f32_32x32x16_bf16 v[136:151], v[184:187], v[32:35], v[136:151]
    ds_read_b128 v[40:43], v9 offset:24576
    ds_read_b64_tr_b16 v[216:217], v13 offset:40960
    ds_read_b64_tr_b16 v[218:219], v13 offset:41472
    ds_read_b64_tr_b16 v[220:221], v13 offset:41216
    ds_read_b64_tr_b16 v[222:223], v13 offset:41728
    v_mfma_f32_32x32x16_bf16 v[152:167], v[188:191], v[32:35], v[152:167]
    ds_read_b128 v[44:47], v10 offset:24576
    ds_read_b64_tr_b16 v[224:225], v13 offset:43008
    ds_read_b64_tr_b16 v[226:227], v13 offset:43520
    ds_read_b64_tr_b16 v[228:229], v13 offset:43264
    ds_read_b64_tr_b16 v[230:231], v13 offset:43776
    v_mfma_f32_32x32x16_bf16 v[136:151], v[192:195], v[36:39], v[136:151]
    ds_read_b128 v[48:51], v11 offset:24576
    ds_read_b64_tr_b16 v[232:233], v13 offset:45056
    ds_read_b64_tr_b16 v[234:235], v13 offset:45568
    ds_read_b64_tr_b16 v[236:237], v13 offset:45312
    ds_read_b64_tr_b16 v[238:239], v13 offset:45824
    v_mfma_f32_32x32x16_bf16 v[152:167], v[196:199], v[36:39], v[152:167]
    ds_read_b128 v[52:55], v12 offset:24576
    ds_read_b64_tr_b16 v[240:241], v13 offset:47104
    ds_read_b64_tr_b16 v[242:243], v13 offset:47616
    ds_read_b64_tr_b16 v[244:245], v13 offset:47360
    ds_read_b64_tr_b16 v[246:247], v13 offset:47872
    s_waitcnt lgkmcnt(15)
    v_dot2c_f32_bf16 v204, s62, v208
    v_dot2c_f32_bf16 v205, s62, v212
    v_dot2c_f32_bf16 v204, s62, v209
    v_dot2c_f32_bf16 v205, s62, v213
    v_dot2c_f32_bf16 v204, s62, v210
    v_dot2c_f32_bf16 v205, s62, v214
    v_dot2c_f32_bf16 v204, s62, v211
    v_dot2c_f32_bf16 v205, s62, v215
    v_dot2c_f32_bf16 v200, s62, v40
    v_dot2c_f32_bf16 v202, v40, v40
    v_dot2c_f32_bf16 v200, s62, v41
    v_dot2c_f32_bf16 v202, v41, v41
    v_dot2c_f32_bf16 v200, s62, v42
    v_dot2c_f32_bf16 v202, v42, v42
    v_dot2c_f32_bf16 v200, s62, v43
    v_dot2c_f32_bf16 v202, v43, v43
    s_waitcnt lgkmcnt(10)
    v_dot2c_f32_bf16 v200, s62, v44
    v_dot2c_f32_bf16 v202, v44, v44
    v_dot2c_f32_bf16 v200, s62, v45
    v_dot2c_f32_bf16 v202, v45, v45
    v_dot2c_f32_bf16 v200, s62, v46
    v_dot2c_f32_bf16 v202, v46, v46
    v_dot2c_f32_bf16 v200, s62, v47
    v_dot2c_f32_bf16 v202, v47, v47
    s_waitcnt lgkmcnt(5)
    v_dot2c_f32_bf16 v200, s62, v48
    v_dot2c_f32_bf16 v202, v48, v48
    v_dot2c_f32_bf16 v200, s62, v49
    v_dot2c_f32_bf16 v202, v49, v49
    v_dot2c_f32_bf16 v200, s62, v50
    v_dot2c_f32_bf16 v202, v50, v50
    v_dot2c_f32_bf16 v200, s62, v51
    v_dot2c_f32_bf16 v202, v51, v51
    s_waitcnt lgkmcnt(0)
    v_dot2c_f32_bf16 v200, s62, v52
    v_dot2c_f32_bf16 v202, v52, v52
    v_dot2c_f32_bf16 v200, s62, v53
    v_dot2c_f32_bf16 v202, v53, v53
    v_dot2c_f32_bf16 v200, s62, v54
    v_dot2c_f32_bf16 v202, v54, v54
    v_dot2c_f32_bf16 v200, s62, v55
    v_dot2c_f32_bf16 v202, v55, v55
    v_add_u32 v9, 49152, v9
    v_add_u32 v10, 49152, v10
    v_add_u32 v11, 49152, v11
    v_add_u32 v12, 49152, v12
    v_add_u32 v13, 49152, v13
    v_add_u32 v5, 49152, v5
    v_mfma_f32_32x32x16_bf16 v[136:151], v[216:219], v[40:43], v[136:151]
    v_mfma_f32_32x32x16_bf16 v[152:167], v[220:223], v[40:43], v[152:167]
    v_mfma_f32_32x32x16_bf16 v[136:151], v[224:227], v[44:47], v[136:151]
    v_mfma_f32_32x32x16_bf16 v[152:167], v[228:231], v[44:47], v[152:167]
    s_barrier
    ds_read_b64_tr_b16 v[208:209], v5 offset:16384
    ds_read_b64_tr_b16 v[210:211], v5 offset:16896
    ds_read_b64_tr_b16 v[212:213], v5 offset:16640
    ds_read_b64_tr_b16 v[214:215], v5 offset:17152
    v_mfma_f32_32x32x16_bf16 v[136:151], v[232:235], v[48:51], v[136:151]
    ds_read_b128 v[56:59], v9 offset:0
    ds_read_b64_tr_b16 v[168:169], v13 offset:16384
    ds_read_b64_tr_b16 v[170:171], v13 offset:16896
    ds_read_b64_tr_b16 v[172:173], v13 offset:16640
    ds_read_b64_tr_b16 v[174:175], v13 offset:17152
    v_mfma_f32_32x32x16_bf16 v[152:167], v[236:239], v[48:51], v[152:167]
    ds_read_b128 v[60:63], v10 offset:0
    ds_read_b64_tr_b16 v[176:177], v13 offset:18432
    ds_read_b64_tr_b16 v[178:179], v13 offset:18944
    ds_read_b64_tr_b16 v[180:181], v13 offset:18688
    ds_read_b64_tr_b16 v[182:183], v13 offset:19200
    v_mfma_f32_32x32x16_bf16 v[136:151], v[240:243], v[52:55], v[136:151]
    ds_read_b128 v[64:67], v11 offset:0
    ds_read_b64_tr_b16 v[184:185], v13 offset:20480
    ds_read_b64_tr_b16 v[186:187], v13 offset:20992
    ds_read_b64_tr_b16 v[188:189], v13 offset:20736
    ds_read_b64_tr_b16 v[190:191], v13 offset:21248
    v_mfma_f32_32x32x16_bf16 v[152:167], v[244:247], v[52:55], v[152:167]
    ds_read_b128 v[68:71], v12 offset:0
    ds_read_b64_tr_b16 v[192:193], v13 offset:22528
    ds_read_b64_tr_b16 v[194:195], v13 offset:23040
    ds_read_b64_tr_b16 v[196:197], v13 offset:22784
    ds_read_b64_tr_b16 v[198:199], v13 offset:23296
    s_waitcnt lgkmcnt(15)
    v_dot2c_f32_bf16 v204, s62, v208
    v_dot2c_f32_bf16 v205, s62, v212
    v_dot2c_f32_bf16 v204, s62, v209
    v_dot2c_f32_bf16 v205, s62, v213
    v_dot2c_f32_bf16 v204, s62, v210
    v_dot2c_f32_bf16 v205, s62, v214
    v_dot2c_f32_bf16 v204, s62, v211
    v_dot2c_f32_bf16 v205, s62, v215
    v_dot2c_f32_bf16 v200, s62, v56
    v_dot2c_f32_bf16 v202, v56, v56
    v_dot2c_f32_bf16 v200, s62, v57
    v_dot2c_f32_bf16 v202, v57, v57
    v_dot2c_f32_bf16 v200, s62, v58
    v_dot2c_f32_bf16 v202, v58, v58
    v_dot2c_f32_bf16 v200, s62, v59
    v_dot2c_f32_bf16 v202, v59, v59
    s_waitcnt lgkmcnt(10)
    v_dot2c_f32_bf16 v200, s62, v60
    v_dot2c_f32_bf16 v202, v60, v60
    v_dot2c_f32_bf16 v200, s62, v61
    v_dot2c_f32_bf16 v202, v61, v61
    v_dot2c_f32_bf16 v200, s62, v62
    v_dot2c_f32_bf16 v202, v62, v62
    v_dot2c_f32_bf16 v200, s62, v63
    v_dot2c_f32_bf16 v202, v63, v63
    s_waitcnt lgkmcnt(5)
    v_dot2c_f32_bf16 v200, s62, v64
    v_dot2c_f32_bf16 v202, v64, v64
    v_dot2c_f32_bf16 v200, s62, v65
    v_dot2c_f32_bf16 v202, v65, v65
    v_dot2c_f32_bf16 v200, s62, v66
    v_dot2c_f32_bf16 v202, v66, v66
    v_dot2c_f32_bf16 v200, s62, v67
    v_dot2c_f32_bf16 v202, v67, v67
    s_waitcnt lgkmcnt(0)
    v_dot2c_f32_bf16 v200, s62, v68
    v_dot2c_f32_bf16 v202, v68, v68
    v_dot2c_f32_bf16 v200, s62, v69
    v_dot2c_f32_bf16 v202, v69, v69
    v_dot2c_f32_bf16 v200, s62, v70
    v_dot2c_f32_bf16 v202, v70, v70
    v_dot2c_f32_bf16 v200, s62, v71
    v_dot2c_f32_bf16 v202, v71, v71
    v_mfma_f32_32x32x16_bf16 v[136:151], v[168:171], v[56:59], v[136:151]
    v_mfma_f32_32x32x16_bf16 v[152:167], v[172:175], v[56:59], v[152:167]
    v_mfma_f32_32x32x16_bf16 v[136:151], v[176:179], v[60:63], v[136:151]
    v_mfma_f32_32x32x16_bf16 v[152:167], v[180:183], v[60:63], v[152:167]
    s_barrier
    ds_read_b64_tr_b16 v[208:209], v5 offset:40960
    ds_read_b64_tr_b16 v[210:211], v5 offset:41472
    ds_read_b64_tr_b16 v[212:213], v5 offset:41216
    ds_read_b64_tr_b16 v[214:215], v5 offset:41728
    v_mfma_f32_32x32x16_bf16 v[136:151], v[184:187], v[64:67], v[136:151]
    ds_read_b128 v[72:75], v9 offset:24576
    ds_read_b64_tr_b16 v[216:217], v13 offset:40960
    ds_read_b64_tr_b16 v[218:219], v13 offset:41472
    ds_read_b64_tr_b16 v[220:221], v13 offset:41216
    ds_read_b64_tr_b16 v[222:223], v13 offset:41728
    v_mfma_f32_32x32x16_bf16 v[152:167], v[188:191], v[64:67], v[152:167]
    ds_read_b128 v[76:79], v10 offset:24576
    ds_read_b64_tr_b16 v[224:225], v13 offset:43008
    ds_read_b64_tr_b16 v[226:227], v13 offset:43520
    ds_read_b64_tr_b16 v[228:229], v13 offset:43264
    ds_read_b64_tr_b16 v[230:231], v13 offset:43776
    v_mfma_f32_32x32x16_bf16 v[136:151], v[192:195], v[68:71], v[136:151]
    ds_read_b128 v[80:83], v11 offset:24576
    ds_read_b64_tr_b16 v[232:233], v13 offset:45056
    ds_read_b64_tr_b16 v[234:235], v13 offset:45568
    ds_read_b64_tr_b16 v[236:237], v13 offset:45312
    ds_read_b64_tr_b16 v[238:239], v13 offset:45824
    v_mfma_f32_32x32x16_bf16 v[152:167], v[196:199], v[68:71], v[152:167]
    ds_read_b128 v[84:87], v12 offset:24576
    ds_read_b64_tr_b16 v[240:241], v13 offset:47104
    ds_read_b64_tr_b16 v[242:243], v13 offset:47616
    ds_read_b64_tr_b16 v[244:245], v13 offset:47360
    ds_read_b64_tr_b16 v[246:247], v13 offset:47872
    s_waitcnt lgkmcnt(15)
    v_dot2c_f32_bf16 v204, s62, v208
    v_dot2c_f32_bf16 v205, s62, v212
    v_dot2c_f32_bf16 v204, s62, v209
    v_dot2c_f32_bf16 v205, s62, v213
    v_dot2c_f32_bf16 v204, s62, v210
    v_dot2c_f32_bf16 v205, s62, v214
    v_dot2c_f32_bf16 v204, s62, v211
    v_dot2c_f32_bf16 v205, s62, v215
    v_dot2c_f32_bf16 v200, s62, v72
    v_dot2c_f32_bf16 v202, v72, v72
    v_dot2c_f32_bf16 v200, s62, v73
    v_dot2c_f32_bf16 v202, v73, v73
    v_dot2c_f32_bf16 v200, s62, v74
    v_dot2c_f32_bf16 v202, v74, v74
    v_dot2c_f32_bf16 v200, s62, v75
    v_dot2c_f32_bf16 v202, v75, v75
    s_waitcnt lgkmcnt(10)
    v_dot2c_f32_bf16 v200, s62, v76
    v_dot2c_f32_bf16 v202, v76, v76
    v_dot2c_f32_bf16 v200, s62, v77
    v_dot2c_f32_bf16 v202, v77, v77
    v_dot2c_f32_bf16 v200, s62, v78
    v_dot2c_f32_bf16 v202, v78, v78
    v_dot2c_f32_bf16 v200, s62, v79
    v_dot2c_f32_bf16 v202, v79, v79
    s_waitcnt lgkmcnt(5)
    v_dot2c_f32_bf16 v200, s62, v80
    v_dot2c_f32_bf16 v202, v80, v80
    v_dot2c_f32_bf16 v200, s62, v81
    v_dot2c_f32_bf16 v202, v81, v81
    v_dot2c_f32_bf16 v200, s62, v82
    v_dot2c_f32_bf16 v202, v82, v82
    v_dot2c_f32_bf16 v200, s62, v83
    v_dot2c_f32_bf16 v202, v83, v83
    s_waitcnt lgkmcnt(0)
    v_dot2c_f32_bf16 v200, s62, v84
    v_dot2c_f32_bf16 v202, v84, v84
    v_dot2c_f32_bf16 v200, s62, v85
    v_dot2c_f32_bf16 v202, v85, v85
    v_dot2c_f32_bf16 v200, s62, v86
    v_dot2c_f32_bf16 v202, v86, v86
    v_dot2c_f32_bf16 v200, s62, v87
    v_dot2c_f32_bf16 v202, v87, v87
    v_add_u32 v9, 49152, v9
    v_add_u32 v10, 49152, v10
    v_add_u32 v11, 49152, v11
    v_add_u32 v12, 49152, v12
    v_add_u32 v13, 49152, v13
    v_add_u32 v5, 49152, v5
    v_mfma_f32_32x32x16_bf16 v[136:151], v[216:219], v[72:75], v[136:151]
    v_mfma_f32_32x32x16_bf16 v[152:167], v[220:223], v[72:75], v[152:167]
    v_mfma_f32_32x32x16_bf16 v[136:151], v[224:227], v[76:79], v[136:151]
    v_mfma_f32_32x32x16_bf16 v[152:167], v[228:231], v[76:79], v[152:167]
    s_barrier
    ds_read_b64_tr_b16 v[208:209], v5 offset:16384
    ds_read_b64_tr_b16 v[210:211], v5 offset:16896
    ds_read_b64_tr_b16 v[212:213], v5 offset:16640
    ds_read_b64_tr_b16 v[214:215], v5 offset:17152
    v_mfma_f32_32x32x16_bf16 v[136:151], v[232:235], v[80:83], v[136:151]
    ds_read_b128 v[88:91], v9 offset:0
    ds_read_b64_tr_b16 v[168:169], v13 offset:16384
    ds_read_b64_tr_b16 v[170:171], v13 offset:16896
    ds_read_b64_tr_b16 v[172:173], v13 offset:16640
    ds_read_b64_tr_b16 v[174:175], v13 offset:17152
    v_mfma_f32_32x32x16_bf16 v[152:167], v[236:239], v[80:83], v[152:167]
    ds_read_b128 v[92:95], v10 offset:0
    ds_read_b64_tr_b16 v[176:177], v13 offset:18432
    ds_read_b64_tr_b16 v[178:179], v13 offset:18944
    ds_read_b64_tr_b16 v[180:181], v13 offset:18688
    ds_read_b64_tr_b16 v[182:183], v13 offset:19200
    v_mfma_f32_32x32x16_bf16 v[136:151], v[240:243], v[84:87], v[136:151]
    ds_read_b128 v[96:99], v11 offset:0
    ds_read_b64_tr_b16 v[184:185], v13 offset:20480
    ds_read_b64_tr_b16 v[186:187], v13 offset:20992
    ds_read_b64_tr_b16 v[188:189], v13 offset:20736
    ds_read_b64_tr_b16 v[190:191], v13 offset:21248
    v_mfma_f32_32x32x16_bf16 v[152:167], v[244:247], v[84:87], v[152:167]
    ds_read_b128 v[100:103], v12 offset:0
    ds_read_b64_tr_b16 v[192:193], v13 offset:22528
    ds_read_b64_tr_b16 v[194:195], v13 offset:23040
    ds_read_b64_tr_b16 v[196:197], v13 offset:22784
    ds_read_b64_tr_b16 v[198:199], v13 offset:23296
    s_waitcnt lgkmcnt(15)
    v_dot2c_f32_bf16 v204, s62, v208
    v_dot2c_f32_bf16 v205, s62, v212
    v_dot2c_f32_bf16 v204, s62, v209
    v_dot2c_f32_bf16 v205, s62, v213
    v_dot2c_f32_bf16 v204, s62, v210
    v_dot2c_f32_bf16 v205, s62, v214
    v_dot2c_f32_bf16 v204, s62, v211
    v_dot2c_f32_bf16 v205, s62, v215
    v_dot2c_f32_bf16 v200, s62, v88
    v_dot2c_f32_bf16 v202, v88, v88
    v_dot2c_f32_bf16 v200, s62, v89
    v_dot2c_f32_bf16 v202, v89, v89
    v_dot2c_f32_bf16 v200, s62, v90
    v_dot2c_f32_bf16 v202, v90, v90
    v_dot2c_f32_bf16 v200, s62, v91
    v_dot2c_f32_bf16 v202, v91, v91
    s_waitcnt lgkmcnt(10)
    v_dot2c_f32_bf16 v200, s62, v92
    v_dot2c_f32_bf16 v202, v92, v92
    v_dot2c_f32_bf16 v200, s62, v93
    v_dot2c_f32_bf16 v202, v93, v93
    v_dot2c_f32_bf16 v200, s62, v94
    v_dot2c_f32_bf16 v202, v94, v94
    v_dot2c_f32_bf16 v200, s62, v95
    v_dot2c_f32_bf16 v202, v95, v95
    s_waitcnt lgkmcnt(5)
    v_dot2c_f32_bf16 v200, s62, v96
    v_dot2c_f32_bf16 v202, v96, v96
    v_dot2c_f32_bf16 v200, s62, v97
    v_dot2c_f32_bf16 v202, v97, v97
    v_dot2c_f32_bf16 v200, s62, v98
    v_dot2c_f32_bf16 v202, v98, v98
    v_dot2c_f32_bf16 v200, s62, v99
    v_dot2c_f32_bf16 v202, v99, v99
    s_waitcnt lgkmcnt(0)
    v_dot2c_f32_bf16 v200, s62, v100
    v_dot2c_f32_bf16 v202, v100, v100
    v_dot2c_f32_bf16 v200, s62, v101
    v_dot2c_f32_bf16 v202, v101, v101
    v_dot2c_f32_bf16 v200, s62, v102
    v_dot2c_f32_bf16 v202, v102, v102
    v_dot2c_f32_bf16 v200, s62, v103
    v_dot2c_f32_bf16 v202, v103, v103
    v_mfma_f32_32x32x16_bf16 v[136:151], v[168:171], v[88:91], v[136:151]
    v_mfma_f32_32x32x16_bf16 v[152:167], v[172:175], v[88:91], v[152:167]
    v_mfma_f32_32x32x16_bf16 v[136:151], v[176:179], v[92:95], v[136:151]
    v_mfma_f32_32x32x16_bf16 v[152:167], v[180:183], v[92:95], v[152:167]
    s_barrier
    ds_read_b64_tr_b16 v[208:209], v5 offset:40960
    ds_read_b64_tr_b16 v[210:211], v5 offset:41472
    ds_read_b64_tr_b16 v[212:213], v5 offset:41216
    ds_read_b64_tr_b16 v[214:215], v5 offset:41728
    v_mfma_f32_32x32x16_bf16 v[136:151], v[184:187], v[96:99], v[136:151]
    ds_read_b128 v[104:107], v9 offset:24576
    ds_read_b64_tr_b16 v[216:217], v13 offset:40960
    ds_read_b64_tr_b16 v[218:219], v13 offset:41472
    ds_read_b64_tr_b16 v[220:221], v13 offset:41216
    ds_read_b64_tr_b16 v[222:223], v13 offset:41728
    v_mfma_f32_32x32x16_bf16 v[152:167], v[188:191], v[96:99], v[152:167]
    ds_read_b128 v[108:111], v10 offset:24576
    ds_read_b64_tr_b16 v[224:225], v13 offset:43008
    ds_read_b64_tr_b16 v[226:227], v13 offset:43520
    ds_read_b64_tr_b16 v[228:229], v13 offset:43264
    ds_read_b64_tr_b16 v[230:231], v13 offset:43776
    v_mfma_f32_32x32x16_bf16 v[136:151], v[192:195], v[100:103], v[136:151]
    ds_read_b128 v[112:115], v11 offset:24576
    ds_read_b64_tr_b16 v[232:233], v13 offset:45056
    ds_read_b64_tr_b16 v[234:235], v13 offset:45568
    ds_read_b64_tr_b16 v[236:237], v13 offset:45312
    ds_read_b64_tr_b16 v[238:239], v13 offset:45824
    v_mfma_f32_32x32x16_bf16 v[152:167], v[196:199], v[100:103], v[152:167]
    ds_read_b128 v[116:119], v12 offset:24576
    ds_read_b64_tr_b16 v[240:241], v13 offset:47104
    ds_read_b64_tr_b16 v[242:243], v13 offset:47616
    ds_read_b64_tr_b16 v[244:245], v13 offset:47360
    ds_read_b64_tr_b16 v[246:247], v13 offset:47872
    s_waitcnt lgkmcnt(15)
    v_dot2c_f32_bf16 v204, s62, v208
    v_dot2c_f32_bf16 v205, s62, v212
    v_dot2c_f32_bf16 v204, s62, v209
    v_dot2c_f32_bf16 v205, s62, v213
    v_dot2c_f32_bf16 v204, s62, v210
    v_dot2c_f32_bf16 v205, s62, v214
    v_dot2c_f32_bf16 v204, s62, v211
    v_dot2c_f32_bf16 v205, s62, v215
    v_dot2c_f32_bf16 v200, s62, v104
    v_dot2c_f32_bf16 v202, v104, v104
    v_dot2c_f32_bf16 v200, s62, v105
    v_dot2c_f32_bf16 v202, v105, v105
    v_dot2c_f32_bf16 v200, s62, v106
    v_dot2c_f32_bf16 v202, v106, v106
    v_dot2c_f32_bf16 v200, s62, v107
    v_dot2c_f32_bf16 v202, v107, v107
    s_waitcnt lgkmcnt(10)
    v_dot2c_f32_bf16 v200, s62, v108
    v_dot2c_f32_bf16 v202, v108, v108
    v_dot2c_f32_bf16 v200, s62, v109
    v_dot2c_f32_bf16 v202, v109, v109
    v_dot2c_f32_bf16 v200, s62, v110
    v_dot2c_f32_bf16 v202, v110, v110
    v_dot2c_f32_bf16 v200, s62, v111
    v_dot2c_f32_bf16 v202, v111, v111
    s_waitcnt lgkmcnt(5)
    v_dot2c_f32_bf16 v200, s62, v112
    v_dot2c_f32_bf16 v202, v112, v112
    v_dot2c_f32_bf16 v200, s62, v113
    v_dot2c_f32_bf16 v202, v113, v113
    v_dot2c_f32_bf16 v200, s62, v114
    v_dot2c_f32_bf16 v202, v114, v114
    v_dot2c_f32_bf16 v200, s62, v115
    v_dot2c_f32_bf16 v202, v115, v115
    s_waitcnt lgkmcnt(0)
    v_dot2c_f32_bf16 v200, s62, v116
    v_dot2c_f32_bf16 v202, v116, v116
    v_dot2c_f32_bf16 v200, s62, v117
    v_dot2c_f32_bf16 v202, v117, v117
    v_dot2c_f32_bf16 v200, s62, v118
    v_dot2c_f32_bf16 v202, v118, v118
    v_dot2c_f32_bf16 v200, s62, v119
    v_dot2c_f32_bf16 v202, v119, v119
    v_subrev_u32 v9, 98304, v9
    v_subrev_u32 v10, 98304, v10
    v_subrev_u32 v11, 98304, v11
    v_subrev_u32 v12, 98304, v12
    v_subrev_u32 v13, 98304, v13
    v_subrev_u32 v5, 98304, v5
    v_mfma_f32_32x32x16_bf16 v[136:151], v[216:219], v[104:107], v[136:151]
    v_mfma_f32_32x32x16_bf16 v[152:167], v[220:223], v[104:107], v[152:167]
    v_mfma_f32_32x32x16_bf16 v[136:151], v[224:227], v[108:111], v[136:151]
    v_mfma_f32_32x32x16_bf16 v[152:167], v[228:231], v[108:111], v[152:167]
    s_barrier
    ds_read_b64_tr_b16 v[208:209], v5 offset:16384
    ds_read_b64_tr_b16 v[210:211], v5 offset:16896
    ds_read_b64_tr_b16 v[212:213], v5 offset:16640
    ds_read_b64_tr_b16 v[214:215], v5 offset:17152
    v_mfma_f32_32x32x16_bf16 v[136:151], v[232:235], v[112:115], v[136:151]
    ds_read_b128 v[120:123], v9 offset:0
    ds_read_b64_tr_b16 v[168:169], v13 offset:16384
    ds_read_b64_tr_b16 v[170:171], v13 offset:16896
    ds_read_b64_tr_b16 v[172:173], v13 offset:16640
    ds_read_b64_tr_b16 v[174:175], v13 offset:17152
    v_mfma_f32_32x32x16_bf16 v[152:167], v[236:239], v[112:115], v[152:167]
    ds_read_b128 v[124:127], v10 offset:0
    ds_read_b64_tr_b16 v[176:177], v13 offset:18432
    ds_read_b64_tr_b16 v[178:179], v13 offset:18944
    ds_read_b64_tr_b16 v[180:181], v13 offset:18688
    ds_read_b64_tr_b16 v[182:183], v13 offset:19200
    v_mfma_f32_32x32x16_bf16 v[136:151], v[240:243], v[116:119], v[136:151]
    ds_read_b128 v[128:131], v11 offset:0
    ds_read_b64_tr_b16 v[184:185], v13 offset:20480
    ds_read_b64_tr_b16 v[186:187], v13 offset:20992
    ds_read_b64_tr_b16 v[188:189], v13 offset:20736
    ds_read_b64_tr_b16 v[190:191], v13 offset:21248
    v_mfma_f32_32x32x16_bf16 v[152:167], v[244:247], v[116:119], v[152:167]
    ds_read_b128 v[132:135], v12 offset:0
    ds_read_b64_tr_b16 v[192:193], v13 offset:22528
    ds_read_b64_tr_b16 v[194:195], v13 offset:23040
    ds_read_b64_tr_b16 v[196:197], v13 offset:22784
    ds_read_b64_tr_b16 v[198:199], v13 offset:23296
    s_waitcnt lgkmcnt(15)
    v_dot2c_f32_bf16 v204, s62, v208
    v_dot2c_f32_bf16 v205, s62, v212
    v_dot2c_f32_bf16 v204, s62, v209
    v_dot2c_f32_bf16 v205, s62, v213
    v_dot2c_f32_bf16 v204, s62, v210
    v_dot2c_f32_bf16 v205, s62, v214
    v_dot2c_f32_bf16 v204, s62, v211
    v_dot2c_f32_bf16 v205, s62, v215
    v_dot2c_f32_bf16 v200, s62, v120
    v_dot2c_f32_bf16 v202, v120, v120
    v_dot2c_f32_bf16 v200, s62, v121
    v_dot2c_f32_bf16 v202, v121, v121
    v_dot2c_f32_bf16 v200, s62, v122
    v_dot2c_f32_bf16 v202, v122, v122
    v_dot2c_f32_bf16 v200, s62, v123
    v_dot2c_f32_bf16 v202, v123, v123
    v_and_b32 v16, s35, v204
    v_sub_f32 v17, v204, v16
    v_lshrrev_b32 v16, 16, v16
    v_and_or_b32 v204, v17, s35, v16
    ds_write_b32 v0, v204 offset:5120
    v_and_b32 v16, s35, v205
    v_sub_f32 v17, v205, v16
    v_lshrrev_b32 v16, 16, v16
    v_and_or_b32 v205, v17, s35, v16
    ds_write_b32 v0, v205 offset:6144
    v_mov_b32 v16, 1
    ds_write_b32 v252, v16 offset:32
    s_waitcnt lgkmcnt(10)
    v_dot2c_f32_bf16 v200, s62, v124
    v_dot2c_f32_bf16 v202, v124, v124
    v_dot2c_f32_bf16 v200, s62, v125
    v_dot2c_f32_bf16 v202, v125, v125
    v_dot2c_f32_bf16 v200, s62, v126
    v_dot2c_f32_bf16 v202, v126, v126
    v_dot2c_f32_bf16 v200, s62, v127
    v_dot2c_f32_bf16 v202, v127, v127
    s_waitcnt lgkmcnt(5)
    v_dot2c_f32_bf16 v200, s62, v128
    v_dot2c_f32_bf16 v202, v128, v128
    v_dot2c_f32_bf16 v200, s62, v129
    v_dot2c_f32_bf16 v202, v129, v129
    v_dot2c_f32_bf16 v200, s62, v130
    v_dot2c_f32_bf16 v202, v130, v130
    v_dot2c_f32_bf16 v200, s62, v131
    v_dot2c_f32_bf16 v202, v131, v131
    s_waitcnt lgkmcnt(0)
    v_dot2c_f32_bf16 v200, s62, v132
    v_dot2c_f32_bf16 v202, v132, v132
    v_dot2c_f32_bf16 v200, s62, v133
    v_dot2c_f32_bf16 v202, v133, v133
    v_dot2c_f32_bf16 v200, s62, v134
    v_dot2c_f32_bf16 v202, v134, v134
    v_dot2c_f32_bf16 v200, s62, v135
    v_dot2c_f32_bf16 v202, v135, v135
    v_mfma_f32_32x32x16_bf16 v[136:151], v[168:171], v[120:123], v[136:151]
    ds_read_b32 v253, v255 offset:48
    v_mov_b32 v201, v200
    v_mov_b32 v203, v202
    s_nop 0
    v_permlane32_swap_b32 v200, v201
    v_permlane32_swap_b32 v202, v203
    v_add_f32 v200, v200, v201
    v_add_f32 v202, v202, v203
    v_mfma_f32_32x32x16_bf16 v[152:167], v[172:175], v[120:123], v[152:167]
    v_mul_f32 v200, 0x3b124925, v200
    v_mul_f32 v202, 0x3b124925, v202
    v_fma_f32 v202, -v200, v200, v202
    v_max_f32 v202, 0, v202
    v_cvt_pk_bf16_f32 v16, v202, v202
    v_and_b32 v16, s35, v16
    v_mfma_f32_32x32x16_bf16 v[136:151], v[176:179], v[124:127], v[136:151]
    v_add_f32 v16, 0x3727c5ac, v16
    v_cvt_pk_bf16_f32 v16, v16, v16
    v_and_b32 v16, s35, v16
    v_sqrt_f32 v16, v16
    s_nop 0
    v_cvt_pk_bf16_f32 v16, v16, v16
    v_and_b32 v16, s35, v16
    v_mfma_f32_32x32x16_bf16 v[152:167], v[180:183], v[124:127], v[152:167]
    v_rcp_f32 v6, v16
    v_cvt_pk_bf16_f32 v20, -v200, -v200
    v_cvt_pk_bf16_f32 v21, -v200, -v200
    v_cvt_pk_bf16_f32 v22, -v200, -v200
    v_cvt_pk_bf16_f32 v23, -v200, -v200
    v_mov_b32 v7, v6
    v_mfma_f32_32x32x16_bf16 v[136:151], v[184:187], v[128:131], v[136:151]
    v_add_u32 v17, 155648, v2
    v_mfma_f32_32x32x16_bf16 v[152:167], v[188:191], v[128:131], v[152:167]
    v_mfma_f32_32x32x16_bf16 v[136:151], v[192:195], v[132:135], v[136:151]
    s_waitcnt lgkmcnt(0)
    v_cmp_gt_u32 vcc, 1, v253
    s_cbranch_vccnz L_SP0
L_SPB0:
    ds_read_b128 v[208:211], v17 offset:5120
    ds_read_b128 v[212:215], v17 offset:6144
    v_mfma_f32_32x32x16_bf16 v[152:167], v[196:199], v[132:135], v[152:167]
    s_waitcnt lgkmcnt(0)
    v_mfma_f32_32x32x16_bf16 v[136:151], v[208:211], v[20:23], v[136:151]
    v_mfma_f32_32x32x16_bf16 v[152:167], v[212:215], v[20:23], v[152:167]
    v_mov_b32 v16, s62
    v_mov_b32 v17, s63
    s_nop 8
    v_pk_mul_f32 v[136:137], v[136:137], v[6:7]
    v_cvt_pk_bf16_f32 v136, v136, v137
    v_pk_mul_f32 v[138:139], v[138:139], v[6:7]
    v_cvt_pk_bf16_f32 v137, v138, v139
    v_pk_mul_f32 v[140:141], v[140:141], v[6:7]
    v_cvt_pk_bf16_f32 v138, v140, v141
    v_pk_mul_f32 v[142:143], v[142:143], v[6:7]
    v_cvt_pk_bf16_f32 v139, v142, v143
    v_pk_mul_f32 v[144:145], v[144:145], v[6:7]
    v_cvt_pk_bf16_f32 v140, v144, v145
    v_pk_mul_f32 v[146:147], v[146:147], v[6:7]
    v_cvt_pk_bf16_f32 v141, v146, v147
    v_pk_mul_f32 v[148:149], v[148:149], v[6:7]
    v_cvt_pk_bf16_f32 v142, v148, v149
    v_pk_mul_f32 v[150:151], v[150:151], v[6:7]
    v_cvt_pk_bf16_f32 v143, v150, v151
    v_cndmask_b32 v142, v142, v16, s[36:37]
    v_cndmask_b32 v143, v143, v17, s[36:37]
    ds_write_b128 v248, v[136:139] offset:0
    ds_write_b128 v248, v[140:143] offset:1024
    v_pk_mul_f32 v[152:153], v[152:153], v[6:7]
    v_cvt_pk_bf16_f32 v152, v152, v153
    v_pk_mul_f32 v[154:155], v[154:155], v[6:7]
    v_cvt_pk_bf16_f32 v153, v154, v155
    v_pk_mul_f32 v[156:157], v[156:157], v[6:7]
    v_cvt_pk_bf16_f32 v154, v156, v157
    v_pk_mul_f32 v[158:159], v[158:159], v[6:7]
    v_cvt_pk_bf16_f32 v155, v158, v159
    v_pk_mul_f32 v[160:161], v[160:161], v[6:7]
    v_cvt_pk_bf16_f32 v156, v160, v161
    v_pk_mul_f32 v[162:163], v[162:163], v[6:7]
    v_cvt_pk_bf16_f32 v157, v162, v163
    v_pk_mul_f32 v[164:165], v[164:165], v[6:7]
    v_cvt_pk_bf16_f32 v158, v164, v165
    v_pk_mul_f32 v[166:167], v[166:167], v[6:7]
    v_cvt_pk_bf16_f32 v159, v166, v167
    v_cndmask_b32 v158, v158, v16, s[36:37]
    v_cndmask_b32 v159, v159, v17, s[36:37]
    ds_write_b128 v248, v[152:155] offset:2048
    ds_write_b128 v248, v[156:159] offset:3072
    s_waitcnt vmcnt(0) lgkmcnt(0)
    s_barrier
    ds_read_b64_tr_b16 v[216:217], v14 offset:24576
    ds_read_b64_tr_b16 v[218:219], v14 offset:25600
    ds_read_b64_tr_b16 v[220:221], v14 offset:24832
    ds_read_b64_tr_b16 v[222:223], v14 offset:25856
    ds_read_b64_tr_b16 v[224:225], v14 offset:25088
    ds_read_b64_tr_b16 v[226:227], v14 offset:26112
    ds_read_b64_tr_b16 v[228:229], v14 offset:25344
    ds_read_b64_tr_b16 v[230:231], v14 offset:26368
    ds_read_b64_tr_b16 v[232:233], v15 offset:28672
    ds_read_b64_tr_b16 v[234:235], v15 offset:28928
    ds_read_b64_tr_b16 v[236:237], v14 offset:29696
    ds_read_b64_tr_b16 v[238:239], v14 offset:30720
    ds_read_b64_tr_b16 v[240:241], v14 offset:29952
    ds_read_b64_tr_b16 v[242:243], v14 offset:30976
    s_mul_i32 s32, s28, 5120
    v_add_u32 v13, s32, v14
    v_add_u32 v3, s32, v15
    v_mov_b32 v8, 0
    v_mov_b32 v9, 0
    v_mov_b32 v10, 0
    v_mov_b32 v11, 0
    v_mov_b32 v12, 0
    s_waitcnt lgkmcnt(8)
    v_mfma_f32_32x32x16_bf16 v[136:151], v[216:219], v[24:27], 0
    ds_read_b64_tr_b16 v[244:245], v14 offset:30208
    ds_read_b64_tr_b16 v[246:247], v14 offset:31232
    v_mfma_f32_32x32x16_bf16 v[152:167], v[220:223], v[24:27], 0
    ds_read_b64_tr_b16 v[216:217], v14 offset:30464
    ds_read_b64_tr_b16 v[218:219], v14 offset:31488
    v_mfma_f32_32x32x16_bf16 v[168:183], v[224:227], v[24:27], 0
    ds_read_b64_tr_b16 v[220:221], v15 offset:33792
    ds_read_b64_tr_b16 v[222:223], v15 offset:34048
    s_waitcnt lgkmcnt(10)
    v_mfma_f32_32x32x16_bf16 v[184:199], v[228:231], v[24:27], 0
    ds_read_b64_tr_b16 v[224:225], v14 offset:34816
    ds_read_b64_tr_b16 v[226:227], v14 offset:35840
    v_mfma_f32_32x32x16_bf16 v[200:215], v[232:235], v[24:27], 0
    ds_read_b64_tr_b16 v[228:229], v14 offset:35072
    ds_read_b64_tr_b16 v[230:231], v14 offset:36096
    s_waitcnt lgkmcnt(8)
    v_mfma_f32_32x32x16_bf16 v[136:151], v[236:239], v[28:31], v[136:151]
    ds_read_b64_tr_b16 v[232:233], v14 offset:35328
    ds_read_b64_tr_b16 v[234:235], v14 offset:36352
    v_mfma_f32_32x32x16_bf16 v[152:167], v[240:243], v[28:31], v[152:167]
    ds_read_b64_tr_b16 v[236:237], v14 offset:35584
    ds_read_b64_tr_b16 v[238:239], v14 offset:36608
    v_mfma_f32_32x32x16_bf16 v[168:183], v[244:247], v[28:31], v[168:183]
    ds_read_b64_tr_b16 v[240:241], v15 offset:38912
    ds_read_b64_tr_b16 v[242:243], v15 offset:39168
    s_waitcnt lgkmcnt(10)
    v_mfma_f32_32x32x16_bf16 v[184:199], v[216:219], v[28:31], v[184:199]
    ds_read_b64_tr_b16 v[244:245], v14 offset:39936
    ds_read_b64_tr_b16 v[246:247], v14 offset:40960
    v_mfma_f32_32x32x16_bf16 v[200:215], v[220:223], v[28:31], v[200:215]
    ds_read_b64_tr_b16 v[216:217], v14 offset:40192
    ds_read_b64_tr_b16 v[218:219], v14 offset:41216
    s_waitcnt lgkmcnt(8)
    v_mfma_f32_32x32x16_bf16 v[136:151], v[224:227], v[32:35], v[136:151]
    ds_read_b64_tr_b16 v[220:221], v14 offset:40448
    ds_read_b64_tr_b16 v[222:223], v14 offset:41472
    v_mfma_f32_32x32x16_bf16 v[152:167], v[228:231], v[32:35], v[152:167]
    ds_read_b64_tr_b16 v[224:225], v14 offset:40704
    ds_read_b64_tr_b16 v[226:227], v14 offset:41728
    v_mfma_f32_32x32x16_bf16 v[168:183], v[232:235], v[32:35], v[168:183]
    ds_read_b64_tr_b16 v[228:229], v15 offset:44032
    ds_read_b64_tr_b16 v[230:231], v15 offset:44288
    s_waitcnt lgkmcnt(10)
    v_mfma_f32_32x32x16_bf16 v[184:199], v[236:239], v[32:35], v[184:199]
    v_add_u32 v14, 49152, v14
    v_add_u32 v15, 49152, v15
    ds_read_b64_tr_b16 v[232:233], v14 offset:0
    ds_read_b64_tr_b16 v[234:235], v14 offset:1024
    v_mfma_f32_32x32x16_bf16 v[200:215], v[240:243], v[32:35], v[200:215]
    ds_read_b64_tr_b16 v[236:237], v14 offset:256
    ds_read_b64_tr_b16 v[238:239], v14 offset:1280
    s_waitcnt lgkmcnt(8)
    v_mfma_f32_32x32x16_bf16 v[136:151], v[244:247], v[36:39], v[136:151]
    ds_read_b64_tr_b16 v[240:241], v14 offset:512
    ds_read_b64_tr_b16 v[242:243], v14 offset:1536
    v_mfma_f32_32x32x16_bf16 v[152:167], v[216:219], v[36:39], v[152:167]
    ds_read_b64_tr_b16 v[244:245], v14 offset:768
    ds_read_b64_tr_b16 v[246:247], v14 offset:1792
    v_mfma_f32_32x32x16_bf16 v[168:183], v[220:223], v[36:39], v[168:183]
    ds_read_b64_tr_b16 v[216:217], v15 offset:4096
    ds_read_b64_tr_b16 v[218:219], v15 offset:4352
    s_waitcnt lgkmcnt(10)
    v_mfma_f32_32x32x16_bf16 v[184:199], v[224:227], v[36:39], v[184:199]
    ds_read_b64_tr_b16 v[220:221], v14 offset:5120
    ds_read_b64_tr_b16 v[222:223], v14 offset:6144
    v_mfma_f32_32x32x16_bf16 v[200:215], v[228:231], v[36:39], v[200:215]
    ds_read_b64_tr_b16 v[224:225], v14 offset:5376
    ds_read_b64_tr_b16 v[226:227], v14 offset:6400
    s_waitcnt lgkmcnt(8)
    v_mfma_f32_32x32x16_bf16 v[136:151], v[232:235], v[40:43], v[136:151]
    ds_read_b64_tr_b16 v[228:229], v14 offset:5632
    ds_read_b64_tr_b16 v[230:231], v14 offset:6656
    ds_read_b64_tr_b16 v[24:25], v13 offset:24576
    ds_read_b64_tr_b16 v[26:27], v13 offset:25600
    v_mfma_f32_32x32x16_bf16 v[152:167], v[236:239], v[40:43], v[152:167]
    ds_read_b64_tr_b16 v[232:233], v14 offset:5888
    ds_read_b64_tr_b16 v[234:235], v14 offset:6912
    ds_read_b64_tr_b16 v[28:29], v13 offset:24832
    ds_read_b64_tr_b16 v[30:31], v13 offset:25856
    v_mfma_f32_32x32x16_bf16 v[168:183], v[240:243], v[40:43], v[168:183]
    ds_read_b64_tr_b16 v[236:237], v15 offset:9216
    ds_read_b64_tr_b16 v[238:239], v15 offset:9472
    ds_read_b64_tr_b16 v[32:33], v13 offset:25088
    ds_read_b64_tr_b16 v[34:35], v13 offset:26112
    s_waitcnt lgkmcnt(15)
    v_mfma_f32_32x32x16_bf16 v[184:199], v[244:247], v[40:43], v[184:199]
    ds_read_b64_tr_b16 v[240:241], v14 offset:10240
    ds_read_b64_tr_b16 v[242:243], v14 offset:11264
    ds_read_b64_tr_b16 v[36:37], v13 offset:25344
    ds_read_b64_tr_b16 v[38:39], v13 offset:26368
    v_mfma_f32_32x32x16_bf16 v[200:215], v[216:219], v[40:43], v[200:215]
    ds_read_b64_tr_b16 v[244:245], v14 offset:10496
    ds_read_b64_tr_b16 v[246:247], v14 offset:11520
    ds_read_b64_tr_b16 v[16:17], v3 offset:28672
    ds_read_b64_tr_b16 v[18:19], v3 offset:28928
    s_waitcnt lgkmcnt(15)
    v_mfma_f32_32x32x16_bf16 v[136:151], v[220:223], v[44:47], v[136:151]
    ds_read_b64_tr_b16 v[216:217], v14 offset:10752
    ds_read_b64_tr_b16 v[218:219], v14 offset:11776
    v_mfma_f32_32x32x16_bf16 v[152:167], v[224:227], v[44:47], v[152:167]
    ds_read_b64_tr_b16 v[220:221], v14 offset:11008
    ds_read_b64_tr_b16 v[222:223], v14 offset:12032
    s_waitcnt lgkmcnt(4)
    v_dot2c_f32_bf16 v8, s62, v24
    v_dot2c_f32_bf16 v9, s62, v28
    v_dot2c_f32_bf16 v10, s62, v32
    v_dot2c_f32_bf16 v11, s62, v36
    v_dot2c_f32_bf16 v12, s62, v16
    v_dot2c_f32_bf16 v8, s62, v25
    v_dot2c_f32_bf16 v9, s62, v29
    v_dot2c_f32_bf16 v10, s62, v33
    v_dot2c_f32_bf16 v11, s62, v37
    v_dot2c_f32_bf16 v12, s62, v17
    v_dot2c_f32_bf16 v8, s62, v26
    v_dot2c_f32_bf16 v9, s62, v30
    v_dot2c_f32_bf16 v10, s62, v34
    v_dot2c_f32_bf16 v11, s62, v38
    v_dot2c_f32_bf16 v12, s62, v18
    v_dot2c_f32_bf16 v8, s62, v27
    v_dot2c_f32_bf16 v9, s62, v31
    v_dot2c_f32_bf16 v10, s62, v35
    v_dot2c_f32_bf16 v11, s62, v39
    v_dot2c_f32_bf16 v12, s62, v19
    v_mfma_f32_32x32x16_bf16 v[168:183], v[228:231], v[44:47], v[168:183]
    ds_read_b64_tr_b16 v[224:225], v15 offset:14336
    ds_read_b64_tr_b16 v[226:227], v15 offset:14592
    v_mfma_f32_32x32x16_bf16 v[184:199], v[232:235], v[44:47], v[184:199]
    ds_read_b64_tr_b16 v[228:229], v14 offset:15360
    ds_read_b64_tr_b16 v[230:231], v14 offset:16384
    v_mov_b32 v254, 8
    ds_write_b32 v252, v254 offset:64
    v_mfma_f32_32x32x16_bf16 v[200:215], v[236:239], v[44:47], v[200:215]
    ds_read_b64_tr_b16 v[232:233], v14 offset:15616
    ds_read_b64_tr_b16 v[234:235], v14 offset:16640
    s_waitcnt lgkmcnt(9)
    v_mfma_f32_32x32x16_bf16 v[136:151], v[240:243], v[48:51], v[136:151]
    ds_read_b64_tr_b16 v[236:237], v14 offset:15872
    ds_read_b64_tr_b16 v[238:239], v14 offset:16896
    v_add_u32 v13, 49152, v13
    v_add_u32 v3, 49152, v3
    ds_read_b64_tr_b16 v[24:25], v13 offset:0
    ds_read_b64_tr_b16 v[26:27], v13 offset:1024
    v_mfma_f32_32x32x16_bf16 v[152:167], v[244:247], v[48:51], v[152:167]
    ds_read_b64_tr_b16 v[240:241], v14 offset:16128
    ds_read_b64_tr_b16 v[242:243], v14 offset:17152
    ds_read_b64_tr_b16 v[28:29], v13 offset:256
    ds_read_b64_tr_b16 v[30:31], v13 offset:1280
    v_mfma_f32_32x32x16_bf16 v[168:183], v[216:219], v[48:51], v[168:183]
    ds_read_b64_tr_b16 v[244:245], v15 offset:19456
    ds_read_b64_tr_b16 v[246:247], v15 offset:19712
    ds_read_b64_tr_b16 v[32:33], v13 offset:512
    ds_read_b64_tr_b16 v[34:35], v13 offset:1536
    s_waitcnt lgkmcnt(15)
    v_mfma_f32_32x32x16_bf16 v[184:199], v[220:223], v[48:51], v[184:199]
    ds_read_b64_tr_b16 v[216:217], v14 offset:24576
    ds_read_b64_tr_b16 v[218:219], v14 offset:25600
    ds_read_b64_tr_b16 v[36:37], v13 offset:768
    ds_read_b64_tr_b16 v[38:39], v13 offset:1792
    v_mfma_f32_32x32x16_bf16 v[200:215], v[224:227], v[48:51], v[200:215]
    ds_read_b64_tr_b16 v[220:221], v14 offset:24832
    ds_read_b64_tr_b16 v[222:223], v14 offset:25856
    ds_read_b64_tr_b16 v[16:17], v3 offset:4096
    ds_read_b64_tr_b16 v[18:19], v3 offset:4352
    s_waitcnt lgkmcnt(15)
    v_mfma_f32_32x32x16_bf16 v[136:151], v[228:231], v[52:55], v[136:151]
    ds_read_b64_tr_b16 v[224:225], v14 offset:25088
    ds_read_b64_tr_b16 v[226:227], v14 offset:26112
    v_mfma_f32_32x32x16_bf16 v[152:167], v[232:235], v[52:55], v[152:167]
    ds_read_b64_tr_b16 v[228:229], v14 offset:25344
    ds_read_b64_tr_b16 v[230:231], v14 offset:26368
    s_waitcnt lgkmcnt(4)
    v_dot2c_f32_bf16 v8, s62, v24
    v_dot2c_f32_bf16 v9, s62, v28
    v_dot2c_f32_bf16 v10, s62, v32
    v_dot2c_f32_bf16 v11, s62, v36
    v_dot2c_f32_bf16 v12, s62, v16
    v_dot2c_f32_bf16 v8, s62, v25
    v_dot2c_f32_bf16 v9, s62, v29
    v_dot2c_f32_bf16 v10, s62, v33
    v_dot2c_f32_bf16 v11, s62, v37
    v_dot2c_f32_bf16 v12, s62, v17
    v_dot2c_f32_bf16 v8, s62, v26
    v_dot2c_f32_bf16 v9, s62, v30
    v_dot2c_f32_bf16 v10, s62, v34
    v_dot2c_f32_bf16 v11, s62, v38
    v_dot2c_f32_bf16 v12, s62, v18
    v_dot2c_f32_bf16 v8, s62, v27
    v_dot2c_f32_bf16 v9, s62, v31
    v_dot2c_f32_bf16 v10, s62, v35
    v_dot2c_f32_bf16 v11, s62, v39
    v_dot2c_f32_bf16 v12, s62, v19
    v_mfma_f32_32x32x16_bf16 v[168:183], v[236:239], v[52:55], v[168:183]
    ds_read_b64_tr_b16 v[232:233], v15 offset:28672
    ds_read_b64_tr_b16 v[234:235], v15 offset:28928
    v_mfma_f32_32x32x16_bf16 v[184:199], v[240:243], v[52:55], v[184:199]
    ds_read_b64_tr_b16 v[236:237], v14 offset:29696
    ds_read_b64_tr_b16 v[238:239], v14 offset:30720
    v_mfma_f32_32x32x16_bf16 v[200:215], v[244:247], v[52:55], v[200:215]
    ds_read_b64_tr_b16 v[240:241], v14 offset:29952
    ds_read_b64_tr_b16 v[242:243], v14 offset:30976
    s_waitcnt lgkmcnt(8)
    v_mfma_f32_32x32x16_bf16 v[136:151], v[216:219], v[56:59], v[136:151]
    ds_read_b64_tr_b16 v[244:245], v14 offset:30208
    ds_read_b64_tr_b16 v[246:247], v14 offset:31232
    ds_read_b64_tr_b16 v[24:25], v13 offset:24576
    ds_read_b64_tr_b16 v[26:27], v13 offset:25600
    v_mfma_f32_32x32x16_bf16 v[152:167], v[220:223], v[56:59], v[152:167]
    ds_read_b64_tr_b16 v[216:217], v14 offset:30464
    ds_read_b64_tr_b16 v[218:219], v14 offset:31488
    ds_read_b64_tr_b16 v[28:29], v13 offset:24832
    ds_read_b64_tr_b16 v[30:31], v13 offset:25856
    v_mfma_f32_32x32x16_bf16 v[168:183], v[224:227], v[56:59], v[168:183]
    ds_read_b64_tr_b16 v[220:221], v15 offset:33792
    ds_read_b64_tr_b16 v[222:223], v15 offset:34048
    ds_read_b64_tr_b16 v[32:33], v13 offset:25088
    ds_read_b64_tr_b16 v[34:35], v13 offset:26112
    s_waitcnt lgkmcnt(15)
    v_mfma_f32_32x32x16_bf16 v[184:199], v[228:231], v[56:59], v[184:199]
    ds_read_b64_tr_b16 v[224:225], v14 offset:34816
    ds_read_b64_tr_b16 v[226:227], v14 offset:35840
    ds_read_b64_tr_b16 v[36:37], v13 offset:25344
    ds_read_b64_tr_b16 v[38:39], v13 offset:26368
    v_mfma_f32_32x32x16_bf16 v[200:215], v[232:235], v[56:59], v[200:215]
    ds_read_b64_tr_b16 v[228:229], v14 offset:35072
    ds_read_b64_tr_b16 v[230:231], v14 offset:36096
    ds_read_b64_tr_b16 v[16:17], v3 offset:28672
    ds_read_b64_tr_b16 v[18:19], v3 offset:28928
    s_waitcnt lgkmcnt(15)
    v_mfma_f32_32x32x16_bf16 v[136:151], v[236:239], v[60:63], v[136:151]
    ds_read_b64_tr_b16 v[232:233], v14 offset:35328
    ds_read_b64_tr_b16 v[234:235], v14 offset:36352
    v_mfma_f32_32x32x16_bf16 v[152:167], v[240:243], v[60:63], v[152:167]
    ds_read_b64_tr_b16 v[236:237], v14 offset:35584
    ds_read_b64_tr_b16 v[238:239], v14 offset:36608
    s_waitcnt lgkmcnt(4)
    v_dot2c_f32_bf16 v8, s62, v24
    v_dot2c_f32_bf16 v9, s62, v28
    v_dot2c_f32_bf16 v10, s62, v32
    v_dot2c_f32_bf16 v11, s62, v36
    v_dot2c_f32_bf16 v12, s62, v16
    v_dot2c_f32_bf16 v8, s62, v25
    v_dot2c_f32_bf16 v9, s62, v29
    v_dot2c_f32_bf16 v10, s62, v33
    v_dot2c_f32_bf16 v11, s62, v37
    v_dot2c_f32_bf16 v12, s62, v17
    v_dot2c_f32_bf16 v8, s62, v26
    v_dot2c_f32_bf16 v9, s62, v30
    v_dot2c_f32_bf16 v10, s62, v34
    v_dot2c_f32_bf16 v11, s62, v38
    v_dot2c_f32_bf16 v12, s62, v18
    v_dot2c_f32_bf16 v8, s62, v27
    v_dot2c_f32_bf16 v9, s62, v31
    v_dot2c_f32_bf16 v10, s62, v35
    v_dot2c_f32_bf16 v11, s62, v39
    v_dot2c_f32_bf16 v12, s62, v19
    v_mfma_f32_32x32x16_bf16 v[168:183], v[244:247], v[60:63], v[168:183]
    ds_read_b64_tr_b16 v[240:241], v15 offset:38912
    ds_read_b64_tr_b16 v[242:243], v15 offset:39168
    ds_read_b32 v253, v255 offset:64
    v_mfma_f32_32x32x16_bf16 v[184:199], v[216:219], v[60:63], v[184:199]
    ds_read_b64_tr_b16 v[244:245], v14 offset:39936
    ds_read_b64_tr_b16 v[246:247], v14 offset:40960
    v_mfma_f32_32x32x16_bf16 v[200:215], v[220:223], v[60:63], v[200:215]
    ds_read_b64_tr_b16 v[216:217], v14 offset:40192
    ds_read_b64_tr_b16 v[218:219], v14 offset:41216
    s_waitcnt lgkmcnt(9)
    v_mfma_f32_32x32x16_bf16 v[136:151], v[224:227], v[64:67], v[136:151]
    ds_read_b64_tr_b16 v[220:221], v14 offset:40448
    ds_read_b64_tr_b16 v[222:223], v14 offset:41472
    v_mfma_f32_32x32x16_bf16 v[152:167], v[228:231], v[64:67], v[152:167]
    ds_read_b64_tr_b16 v[224:225], v14 offset:40704
    ds_read_b64_tr_b16 v[226:227], v14 offset:41728
    v_mfma_f32_32x32x16_bf16 v[168:183], v[232:235], v[64:67], v[168:183]
    ds_read_b64_tr_b16 v[228:229], v15 offset:44032
    ds_read_b64_tr_b16 v[230:231], v15 offset:44288
    s_waitcnt lgkmcnt(11)
    v_mfma_f32_32x32x16_bf16 v[184:199], v[236:239], v[64:67], v[184:199]
    s_waitcnt lgkmcnt(10)
    v_cmp_gt_u32 vcc, 12, v253
    s_cbranch_vccnz L_SP1
L_SPB1:
    v_add_u32 v14, 49152, v14
    v_add_u32 v15, 49152, v15
    ds_read_b64_tr_b16 v[232:233], v14 offset:0
    ds_read_b64_tr_b16 v[234:235], v14 offset:1024
    v_mfma_f32_32x32x16_bf16 v[200:215], v[240:243], v[64:67], v[200:215]
    ds_read_b64_tr_b16 v[236:237], v14 offset:256
    ds_read_b64_tr_b16 v[238:239], v14 offset:1280
    s_waitcnt lgkmcnt(8)
    v_mfma_f32_32x32x16_bf16 v[136:151], v[244:247], v[68:71], v[136:151]
    ds_read_b64_tr_b16 v[240:241], v14 offset:512
    ds_read_b64_tr_b16 v[242:243], v14 offset:1536
    v_mfma_f32_32x32x16_bf16 v[152:167], v[216:219], v[68:71], v[152:167]
    ds_read_b64_tr_b16 v[244:245], v14 offset:768
    ds_read_b64_tr_b16 v[246:247], v14 offset:1792
    v_mfma_f32_32x32x16_bf16 v[168:183], v[220:223], v[68:71], v[168:183]
    ds_read_b64_tr_b16 v[216:217], v15 offset:4096
    ds_read_b64_tr_b16 v[218:219], v15 offset:4352
    s_waitcnt lgkmcnt(10)
    v_mfma_f32_32x32x16_bf16 v[184:199], v[224:227], v[68:71], v[184:199]
    ds_read_b64_tr_b16 v[220:221], v14 offset:5120
    ds_read_b64_tr_b16 v[222:223], v14 offset:6144
    v_mfma_f32_32x32x16_bf16 v[200:215], v[228:231], v[68:71], v[200:215]
    ds_read_b64_tr_b16 v[224:225], v14 offset:5376
    ds_read_b64_tr_b16 v[226:227], v14 offset:6400
    s_waitcnt lgkmcnt(8)
    v_mfma_f32_32x32x16_bf16 v[136:151], v[232:235], v[72:75], v[136:151]
    ds_read_b64_tr_b16 v[228:229], v14 offset:5632
    ds_read_b64_tr_b16 v[230:231], v14 offset:6656
    v_add_u32 v13, 49152, v13
    v_add_u32 v3, 49152, v3
    ds_read_b64_tr_b16 v[24:25], v13 offset:0
    ds_read_b64_tr_b16 v[26:27], v13 offset:1024
    v_mfma_f32_32x32x16_bf16 v[152:167], v[236:239], v[72:75], v[152:167]
    ds_read_b64_tr_b16 v[232:233], v14 offset:5888
    ds_read_b64_tr_b16 v[234:235], v14 offset:6912
    ds_read_b64_tr_b16 v[28:29], v13 offset:256
    ds_read_b64_tr_b16 v[30:31], v13 offset:1280
    v_mfma_f32_32x32x16_bf16 v[168:183], v[240:243], v[72:75], v[168:183]
    ds_read_b64_tr_b16 v[236:237], v15 offset:9216
    ds_read_b64_tr_b16 v[238:239], v15 offset:9472
    ds_read_b64_tr_b16 v[32:33], v13 offset:512
    ds_read_b64_tr_b16 v[34:35], v13 offset:1536
    s_waitcnt lgkmcnt(15)
    v_mfma_f32_32x32x16_bf16 v[184:199], v[244:247], v[72:75], v[184:199]
    ds_read_b64_tr_b16 v[240:241], v14 offset:10240
    ds_read_b64_tr_b16 v[242:243], v14 offset:11264
    ds_read_b64_tr_b16 v[36:37], v13 offset:768
    ds_read_b64_tr_b16 v[38:39], v13 offset:1792
    v_mfma_f32_32x32x16_bf16 v[200:215], v[216:219], v[72:75], v[200:215]
    ds_read_b64_tr_b16 v[244:245], v14 offset:10496
    ds_read_b64_tr_b16 v[246:247], v14 offset:11520
    ds_read_b64_tr_b16 v[16:17], v3 offset:4096
    ds_read_b64_tr_b16 v[18:19], v3 offset:4352
    s_waitcnt lgkmcnt(15)
    v_mfma_f32_32x32x16_bf16 v[136:151], v[220:223], v[76:79], v[136:151]
    ds_read_b64_tr_b16 v[216:217], v14 offset:10752
    ds_read_b64_tr_b16 v[218:219], v14 offset:11776
    v_mfma_f32_32x32x16_bf16 v[152:167], v[224:227], v[76:79], v[152:167]
    ds_read_b64_tr_b16 v[220:221], v14 offset:11008
    ds_read_b64_tr_b16 v[222:223], v14 offset:12032
    s_waitcnt lgkmcnt(4)
    v_dot2c_f32_bf16 v8, s62, v24
    v_dot2c_f32_bf16 v9, s62, v28
    v_dot2c_f32_bf16 v10, s62, v32
    v_dot2c_f32_bf16 v11, s62, v36
    v_dot2c_f32_bf16 v12, s62, v16
    v_dot2c_f32_bf16 v8, s62, v25
    v_dot2c_f32_bf16 v9, s62, v29
    v_dot2c_f32_bf16 v10, s62, v33
    v_dot2c_f32_bf16 v11, s62, v37
    v_dot2c_f32_bf16 v12, s62, v17
    v_dot2c_f32_bf16 v8, s62, v26
    v_dot2c_f32_bf16 v9, s62, v30
    v_dot2c_f32_bf16 v10, s62, v34
    v_dot2c_f32_bf16 v11, s62, v38
    v_dot2c_f32_bf16 v12, s62, v18
    v_dot2c_f32_bf16 v8, s62, v27
    v_dot2c_f32_bf16 v9, s62, v31
    v_dot2c_f32_bf16 v10, s62, v35
    v_dot2c_f32_bf16 v11, s62, v39
    v_dot2c_f32_bf16 v12, s62, v19
    v_mfma_f32_32x32x16_bf16 v[168:183], v[228:231], v[76:79], v[168:183]
    ds_read_b64_tr_b16 v[224:225], v15 offset:14336
    ds_read_b64_tr_b16 v[226:227], v15 offset:14592
    v_mfma_f32_32x32x16_bf16 v[184:199], v[232:235], v[76:79], v[184:199]
    ds_read_b64_tr_b16 v[228:229], v14 offset:15360
    ds_read_b64_tr_b16 v[230:231], v14 offset:16384
    v_mfma_f32_32x32x16_bf16 v[200:215], v[236:239], v[76:79], v[200:215]
    ds_read_b64_tr_b16 v[232:233], v14 offset:15616
    ds_read_b64_tr_b16 v[234:235], v14 offset:16640
    s_waitcnt lgkmcnt(8)
    v_mfma_f32_32x32x16_bf16 v[136:151], v[240:243], v[80:83], v[136:151]
    ds_read_b64_tr_b16 v[236:237], v14 offset:15872
    ds_read_b64_tr_b16 v[238:239], v14 offset:16896
    v_mfma_f32_32x32x16_bf16 v[152:167], v[244:247], v[80:83], v[152:167]
    ds_read_b64_tr_b16 v[240:241], v14 offset:16128
    ds_read_b64_tr_b16 v[242:243], v14 offset:17152
    v_mfma_f32_32x32x16_bf16 v[168:183], v[216:219], v[80:83], v[168:183]
    ds_read_b64_tr_b16 v[244:245], v15 offset:19456
    ds_read_b64_tr_b16 v[246:247], v15 offset:19712
    s_waitcnt lgkmcnt(10)
    v_mfma_f32_32x32x16_bf16 v[184:199], v[220:223], v[80:83], v[184:199]
    ds_read_b64_tr_b16 v[216:217], v14 offset:24576
    ds_read_b64_tr_b16 v[218:219], v14 offset:25600
    v_mfma_f32_32x32x16_bf16 v[200:215], v[224:227], v[80:83], v[200:215]
    ds_read_b64_tr_b16 v[220:221], v14 offset:24832
    ds_read_b64_tr_b16 v[222:223], v14 offset:25856
    s_waitcnt lgkmcnt(8)
    v_mfma_f32_32x32x16_bf16 v[136:151], v[228:231], v[84:87], v[136:151]
    ds_read_b64_tr_b16 v[224:225], v14 offset:25088
    ds_read_b64_tr_b16 v[226:227], v14 offset:26112
    v_mfma_f32_32x32x16_bf16 v[152:167], v[232:235], v[84:87], v[152:167]
    ds_read_b64_tr_b16 v[228:229], v14 offset:25344
    ds_read_b64_tr_b16 v[230:231], v14 offset:26368
    v_mfma_f32_32x32x16_bf16 v[168:183], v[236:239], v[84:87], v[168:183]
    ds_read_b64_tr_b16 v[232:233], v15 offset:28672
    ds_read_b64_tr_b16 v[234:235], v15 offset:28928
    s_waitcnt lgkmcnt(10)
    v_mfma_f32_32x32x16_bf16 v[184:199], v[240:243], v[84:87], v[184:199]
    ds_read_b64_tr_b16 v[236:237], v14 offset:29696
    ds_read_b64_tr_b16 v[238:239], v14 offset:30720
    v_mfma_f32_32x32x16_bf16 v[200:215], v[244:247], v[84:87], v[200:215]
    ds_read_b64_tr_b16 v[240:241], v14 offset:29952
    ds_read_b64_tr_b16 v[242:243], v14 offset:30976
    s_waitcnt lgkmcnt(8)
    v_mfma_f32_32x32x16_bf16 v[136:151], v[216:219], v[88:91], v[136:151]
    ds_read_b64_tr_b16 v[244:245], v14 offset:30208
    ds_read_b64_tr_b16 v[246:247], v14 offset:31232
    ds_read_b64_tr_b16 v[24:25], v13 offset:24576
    ds_read_b64_tr_b16 v[26:27], v13 offset:25600
    v_mfma_f32_32x32x16_bf16 v[152:167], v[220:223], v[88:91], v[152:167]
    ds_read_b64_tr_b16 v[216:217], v14 offset:30464
    ds_read_b64_tr_b16 v[218:219], v14 offset:31488
    ds_read_b64_tr_b16 v[28:29], v13 offset:24832
    ds_read_b64_tr_b16 v[30:31], v13 offset:25856
    v_mov_b32 v254, 11
    ds_write_b32 v252, v254 offset:64
    v_mfma_f32_32x32x16_bf16 v[168:183], v[224:227], v[88:91], v[168:183]
    ds_read_b64_tr_b16 v[220:221], v15 offset:33792
    ds_read_b64_tr_b16 v[222:223], v15 offset:34048
    ds_read_b64_tr_b16 v[32:33], v13 offset:25088
    ds_read_b64_tr_b16 v[34:35], v13 offset:26112
    s_waitcnt lgkmcnt(15)
    v_mfma_f32_32x32x16_bf16 v[184:199], v[228:231], v[88:91], v[184:199]
    ds_read_b64_tr_b16 v[224:225], v14 offset:34816
    ds_read_b64_tr_b16 v[226:227], v14 offset:35840
    ds_read_b64_tr_b16 v[36:37], v13 offset:25344
    ds_read_b64_tr_b16 v[38:39], v13 offset:26368
    v_mfma_f32_32x32x16_bf16 v[200:215], v[232:235], v[88:91], v[200:215]
    ds_read_b64_tr_b16 v[228:229], v14 offset:35072
    ds_read_b64_tr_b16 v[230:231], v14 offset:36096
    ds_read_b64_tr_b16 v[16:17], v3 offset:28672
    ds_read_b64_tr_b16 v[18:19], v3 offset:28928
    s_waitcnt lgkmcnt(15)
    v_mfma_f32_32x32x16_bf16 v[136:151], v[236:239], v[92:95], v[136:151]
    ds_read_b64_tr_b16 v[232:233], v14 offset:35328
    ds_read_b64_tr_b16 v[234:235], v14 offset:36352
    v_mfma_f32_32x32x16_bf16 v[152:167], v[240:243], v[92:95], v[152:167]
    ds_read_b64_tr_b16 v[236:237], v14 offset:35584
    ds_read_b64_tr_b16 v[238:239], v14 offset:36608
    s_waitcnt lgkmcnt(4)
    v_dot2c_f32_bf16 v8, s62, v24
    v_dot2c_f32_bf16 v9, s62, v28
    v_dot2c_f32_bf16 v10, s62, v32
    v_dot2c_f32_bf16 v11, s62, v36
    v_dot2c_f32_bf16 v12, s62, v16
    v_dot2c_f32_bf16 v8, s62, v25
    v_dot2c_f32_bf16 v9, s62, v29
    v_dot2c_f32_bf16 v10, s62, v33
    v_dot2c_f32_bf16 v11, s62, v37
    v_dot2c_f32_bf16 v12, s62, v17
    v_dot2c_f32_bf16 v8, s62, v26
    v_dot2c_f32_bf16 v9, s62, v30
    v_dot2c_f32_bf16 v10, s62, v34
    v_dot2c_f32_bf16 v11, s62, v38
    v_dot2c_f32_bf16 v12, s62, v18
    v_dot2c_f32_bf16 v8, s62, v27
    v_dot2c_f32_bf16 v9, s62, v31
    v_dot2c_f32_bf16 v10, s62, v35
    v_dot2c_f32_bf16 v11, s62, v39
    v_dot2c_f32_bf16 v12, s62, v19
    v_mfma_f32_32x32x16_bf16 v[168:183], v[244:247], v[92:95], v[168:183]
    ds_read_b64_tr_b16 v[240:241], v15 offset:38912
    ds_read_b64_tr_b16 v[242:243], v15 offset:39168
    ds_read_b32 v253, v255 offset:64
    v_mfma_f32_32x32x16_bf16 v[184:199], v[216:219], v[92:95], v[184:199]
    ds_read_b64_tr_b16 v[244:245], v14 offset:39936
    ds_read_b64_tr_b16 v[246:247], v14 offset:40960
    v_mfma_f32_32x32x16_bf16 v[200:215], v[220:223], v[92:95], v[200:215]
    ds_read_b64_tr_b16 v[216:217], v14 offset:40192
    ds_read_b64_tr_b16 v[218:219], v14 offset:41216
    s_waitcnt lgkmcnt(9)
    v_mfma_f32_32x32x16_bf16 v[136:151], v[224:227], v[96:99], v[136:151]
    ds_read_b64_tr_b16 v[220:221], v14 offset:40448
    ds_read_b64_tr_b16 v[222:223], v14 offset:41472
    v_mfma_f32_32x32x16_bf16 v[152:167], v[228:231], v[96:99], v[152:167]
    ds_read_b64_tr_b16 v[224:225], v14 offset:40704
    ds_read_b64_tr_b16 v[226:227], v14 offset:41728
    v_mfma_f32_32x32x16_bf16 v[168:183], v[232:235], v[96:99], v[168:183]
    ds_read_b64_tr_b16 v[228:229], v15 offset:44032
    ds_read_b64_tr_b16 v[230:231], v15 offset:44288
    s_waitcnt lgkmcnt(11)
    v_mfma_f32_32x32x16_bf16 v[184:199], v[236:239], v[96:99], v[184:199]
    s_waitcnt lgkmcnt(10)
    v_cmp_gt_u32 vcc, 14, v253
    s_cbranch_vccnz L_SP2
L_SPB2:
    v_subrev_u32 v14, 98304, v14
    v_subrev_u32 v15, 98304, v15
    ds_read_b64_tr_b16 v[232:233], v14 offset:0
    ds_read_b64_tr_b16 v[234:235], v14 offset:1024
    v_mfma_f32_32x32x16_bf16 v[200:215], v[240:243], v[96:99], v[200:215]
    ds_read_b64_tr_b16 v[236:237], v14 offset:256
    ds_read_b64_tr_b16 v[238:239], v14 offset:1280
    s_waitcnt lgkmcnt(8)
    v_mfma_f32_32x32x16_bf16 v[136:151], v[244:247], v[100:103], v[136:151]
    ds_read_b64_tr_b16 v[240:241], v14 offset:512
    ds_read_b64_tr_b16 v[242:243], v14 offset:1536
    v_mfma_f32_32x32x16_bf16 v[152:167], v[216:219], v[100:103], v[152:167]
    ds_read_b64_tr_b16 v[244:245], v14 offset:768
    ds_read_b64_tr_b16 v[246:247], v14 offset:1792
    v_mfma_f32_32x32x16_bf16 v[168:183], v[220:223], v[100:103], v[168:183]
    ds_read_b64_tr_b16 v[216:217], v15 offset:4096
    ds_read_b64_tr_b16 v[218:219], v15 offset:4352
    s_waitcnt lgkmcnt(10)
    v_mfma_f32_32x32x16_bf16 v[184:199], v[224:227], v[100:103], v[184:199]
    ds_read_b64_tr_b16 v[220:221], v14 offset:5120
    ds_read_b64_tr_b16 v[222:223], v14 offset:6144
    v_mfma_f32_32x32x16_bf16 v[200:215], v[228:231], v[100:103], v[200:215]
    ds_read_b64_tr_b16 v[224:225], v14 offset:5376
    ds_read_b64_tr_b16 v[226:227], v14 offset:6400
    s_waitcnt lgkmcnt(8)
    v_mfma_f32_32x32x16_bf16 v[136:151], v[232:235], v[104:107], v[136:151]
    ds_read_b64_tr_b16 v[228:229], v14 offset:5632
    ds_read_b64_tr_b16 v[230:231], v14 offset:6656
    v_subrev_u32 v13, 98304, v13
    v_subrev_u32 v3, 98304, v3
    ds_read_b64_tr_b16 v[24:25], v13 offset:0
    ds_read_b64_tr_b16 v[26:27], v13 offset:1024
    v_mfma_f32_32x32x16_bf16 v[152:167], v[236:239], v[104:107], v[152:167]
    ds_read_b64_tr_b16 v[232:233], v14 offset:5888
    ds_read_b64_tr_b16 v[234:235], v14 offset:6912
    ds_read_b64_tr_b16 v[28:29], v13 offset:256
    ds_read_b64_tr_b16 v[30:31], v13 offset:1280
    v_mfma_f32_32x32x16_bf16 v[168:183], v[240:243], v[104:107], v[168:183]
    ds_read_b64_tr_b16 v[236:237], v15 offset:9216
    ds_read_b64_tr_b16 v[238:239], v15 offset:9472
    ds_read_b64_tr_b16 v[32:33], v13 offset:512
    ds_read_b64_tr_b16 v[34:35], v13 offset:1536
    s_waitcnt lgkmcnt(15)
    v_mfma_f32_32x32x16_bf16 v[184:199], v[244:247], v[104:107], v[184:199]
    ds_read_b64_tr_b16 v[240:241], v14 offset:10240
    ds_read_b64_tr_b16 v[242:243], v14 offset:11264
    ds_read_b64_tr_b16 v[36:37], v13 offset:768
    ds_read_b64_tr_b16 v[38:39], v13 offset:1792
    v_mfma_f32_32x32x16_bf16 v[200:215], v[216:219], v[104:107], v[200:215]
    ds_read_b64_tr_b16 v[244:245], v14 offset:10496
    ds_read_b64_tr_b16 v[246:247], v14 offset:11520
    ds_read_b64_tr_b16 v[16:17], v3 offset:4096
    ds_read_b64_tr_b16 v[18:19], v3 offset:4352
    s_waitcnt lgkmcnt(15)
    v_mfma_f32_32x32x16_bf16 v[136:151], v[220:223], v[108:111], v[136:151]
    ds_read_b64_tr_b16 v[216:217], v14 offset:10752
    ds_read_b64_tr_b16 v[218:219], v14 offset:11776
    v_mfma_f32_32x32x16_bf16 v[152:167], v[224:227], v[108:111], v[152:167]
    ds_read_b64_tr_b16 v[220:221], v14 offset:11008
    ds_read_b64_tr_b16 v[222:223], v14 offset:12032
    s_waitcnt lgkmcnt(4)
    v_dot2c_f32_bf16 v8, s62, v24
    v_dot2c_f32_bf16 v9, s62, v28
    v_dot2c_f32_bf16 v10, s62, v32
    v_dot2c_f32_bf16 v11, s62, v36
    v_dot2c_f32_bf16 v12, s62, v16
    v_dot2c_f32_bf16 v8, s62, v25
    v_dot2c_f32_bf16 v9, s62, v29
    v_dot2c_f32_bf16 v10, s62, v33
    v_dot2c_f32_bf16 v11, s62, v37
    v_dot2c_f32_bf16 v12, s62, v17
    v_dot2c_f32_bf16 v8, s62, v26
    v_dot2c_f32_bf16 v9, s62, v30
    v_dot2c_f32_bf16 v10, s62, v34
    v_dot2c_f32_bf16 v11, s62, v38
    v_dot2c_f32_bf16 v12, s62, v18
    v_dot2c_f32_bf16 v8, s62, v27
    v_dot2c_f32_bf16 v9, s62, v31
    v_dot2c_f32_bf16 v10, s62, v35
    v_dot2c_f32_bf16 v11, s62, v39
    v_dot2c_f32_bf16 v12, s62, v19
    v_mfma_f32_32x32x16_bf16 v[168:183], v[228:231], v[108:111], v[168:183]
    ds_read_b64_tr_b16 v[224:225], v15 offset:14336
    ds_read_b64_tr_b16 v[226:227], v15 offset:14592
    v_mfma_f32_32x32x16_bf16 v[184:199], v[232:235], v[108:111], v[184:199]
    ds_read_b64_tr_b16 v[228:229], v14 offset:15360
    ds_read_b64_tr_b16 v[230:231], v14 offset:16384
    v_mfma_f32_32x32x16_bf16 v[200:215], v[236:239], v[108:111], v[200:215]
    ds_read_b64_tr_b16 v[232:233], v14 offset:15616
    ds_read_b64_tr_b16 v[234:235], v14 offset:16640
    s_waitcnt lgkmcnt(8)
    v_mfma_f32_32x32x16_bf16 v[136:151], v[240:243], v[112:115], v[136:151]
    ds_read_b64_tr_b16 v[236:237], v14 offset:15872
    ds_read_b64_tr_b16 v[238:239], v14 offset:16896
    ds_read_b64_tr_b16 v[24:25], v13 offset:24576
    ds_read_b64_tr_b16 v[26:27], v13 offset:25600
    v_mfma_f32_32x32x16_bf16 v[152:167], v[244:247], v[112:115], v[152:167]
    ds_read_b64_tr_b16 v[240:241], v14 offset:16128
    ds_read_b64_tr_b16 v[242:243], v14 offset:17152
    ds_read_b64_tr_b16 v[28:29], v13 offset:24832
    ds_read_b64_tr_b16 v[30:31], v13 offset:25856
    v_mfma_f32_32x32x16_bf16 v[168:183], v[216:219], v[112:115], v[168:183]
    ds_read_b64_tr_b16 v[244:245], v15 offset:19456
    ds_read_b64_tr_b16 v[246:247], v15 offset:19712
    ds_read_b64_tr_b16 v[32:33], v13 offset:25088
    ds_read_b64_tr_b16 v[34:35], v13 offset:26112
    s_waitcnt lgkmcnt(15)
    v_mfma_f32_32x32x16_bf16 v[184:199], v[220:223], v[112:115], v[184:199]
    ds_read_b64_tr_b16 v[216:217], v14 offset:24576
    ds_read_b64_tr_b16 v[218:219], v14 offset:25600
    ds_read_b64_tr_b16 v[36:37], v13 offset:25344
    ds_read_b64_tr_b16 v[38:39], v13 offset:26368
    v_mfma_f32_32x32x16_bf16 v[200:215], v[224:227], v[112:115], v[200:215]
    ds_read_b64_tr_b16 v[220:221], v14 offset:24832
    ds_read_b64_tr_b16 v[222:223], v14 offset:25856
    ds_read_b64_tr_b16 v[16:17], v3 offset:28672
    ds_read_b64_tr_b16 v[18:19], v3 offset:28928
    s_waitcnt lgkmcnt(15)
    v_mfma_f32_32x32x16_bf16 v[136:151], v[228:231], v[116:119], v[136:151]
    ds_read_b64_tr_b16 v[224:225], v14 offset:25088
    ds_read_b64_tr_b16 v[226:227], v14 offset:26112
    v_mfma_f32_32x32x16_bf16 v[152:167], v[232:235], v[116:119], v[152:167]
    ds_read_b64_tr_b16 v[228:229], v14 offset:25344
    ds_read_b64_tr_b16 v[230:231], v14 offset:26368
    s_waitcnt lgkmcnt(4)
    v_dot2c_f32_bf16 v8, s62, v24
    v_dot2c_f32_bf16 v9, s62, v28
    v_dot2c_f32_bf16 v10, s62, v32
    v_dot2c_f32_bf16 v11, s62, v36
    v_dot2c_f32_bf16 v12, s62, v16
    v_dot2c_f32_bf16 v8, s62, v25
    v_dot2c_f32_bf16 v9, s62, v29
    v_dot2c_f32_bf16 v10, s62, v33
    v_dot2c_f32_bf16 v11, s62, v37
    v_dot2c_f32_bf16 v12, s62, v17
    v_dot2c_f32_bf16 v8, s62, v26
    v_dot2c_f32_bf16 v9, s62, v30
    v_dot2c_f32_bf16 v10, s62, v34
    v_dot2c_f32_bf16 v11, s62, v38
    v_dot2c_f32_bf16 v12, s62, v18
    v_dot2c_f32_bf16 v8, s62, v27
    v_dot2c_f32_bf16 v9, s62, v31
    v_dot2c_f32_bf16 v10, s62, v35
    v_dot2c_f32_bf16 v11, s62, v39
    v_dot2c_f32_bf16 v12, s62, v19
    v_mfma_f32_32x32x16_bf16 v[168:183], v[236:239], v[116:119], v[168:183]
    ds_read_b64_tr_b16 v[232:233], v15 offset:28672
    ds_read_b64_tr_b16 v[234:235], v15 offset:28928
    v_and_b32 v16, s35, v8
    v_sub_f32 v17, v8, v16
    v_lshrrev_b32 v16, 16, v16
    v_and_or_b32 v8, v17, s35, v16
    ds_write_b32 v0, v8 offset:0
    v_mfma_f32_32x32x16_bf16 v[184:199], v[240:243], v[116:119], v[184:199]
    ds_read_b64_tr_b16 v[236:237], v14 offset:29696
    ds_read_b64_tr_b16 v[238:239], v14 offset:30720
    v_and_b32 v16, s35, v9
    v_sub_f32 v17, v9, v16
    v_lshrrev_b32 v16, 16, v16
    v_and_or_b32 v9, v17, s35, v16
    ds_write_b32 v0, v9 offset:1024
    v_mfma_f32_32x32x16_bf16 v[200:215], v[244:247], v[116:119], v[200:215]
    ds_read_b64_tr_b16 v[240:241], v14 offset:29952
    ds_read_b64_tr_b16 v[242:243], v14 offset:30976
    v_and_b32 v16, s35, v10
    v_sub_f32 v17, v10, v16
    v_lshrrev_b32 v16, 16, v16
    v_and_or_b32 v10, v17, s35, v16
    ds_write_b32 v0, v10 offset:2048
    s_waitcnt lgkmcnt(11)
    v_mfma_f32_32x32x16_bf16 v[136:151], v[216:219], v[120:123], v[136:151]
    ds_read_b64_tr_b16 v[244:245], v14 offset:30208
    ds_read_b64_tr_b16 v[246:247], v14 offset:31232
    v_and_b32 v16, s35, v11
    v_sub_f32 v17, v11, v16
    v_lshrrev_b32 v16, 16, v16
    v_and_or_b32 v11, v17, s35, v16
    ds_write_b32 v0, v11 offset:3072
    v_mfma_f32_32x32x16_bf16 v[152:167], v[220:223], v[120:123], v[152:167]
    ds_read_b64_tr_b16 v[216:217], v14 offset:30464
    ds_read_b64_tr_b16 v[218:219], v14 offset:31488
    v_and_b32 v16, s35, v12
    v_sub_f32 v17, v12, v16
    v_lshrrev_b32 v16, 16, v16
    v_and_or_b32 v12, v17, s35, v16
    ds_write_b32 v0, v12 offset:4096
    v_mov_b32 v254, 2
    ds_write_b32 v252, v254 offset:32
    v_add_u32 v18, 155648, v2
    v_mfma_f32_32x32x16_bf16 v[168:183], v[224:227], v[120:123], v[168:183]
    ds_read_b64_tr_b16 v[220:221], v15 offset:33792
    ds_read_b64_tr_b16 v[222:223], v15 offset:34048
    s_waitcnt lgkmcnt(15)
    v_mfma_f32_32x32x16_bf16 v[184:199], v[228:231], v[120:123], v[184:199]
    ds_read_b64_tr_b16 v[224:225], v14 offset:34816
    ds_read_b64_tr_b16 v[226:227], v14 offset:35840
    ds_read_b32 v253, v255 offset:80
    v_mfma_f32_32x32x16_bf16 v[200:215], v[232:235], v[120:123], v[200:215]
    ds_read_b64_tr_b16 v[228:229], v14 offset:35072
    ds_read_b64_tr_b16 v[230:231], v14 offset:36096
    s_waitcnt lgkmcnt(12)
    v_mfma_f32_32x32x16_bf16 v[136:151], v[236:239], v[124:127], v[136:151]
    ds_read_b64_tr_b16 v[232:233], v14 offset:35328
    ds_read_b64_tr_b16 v[234:235], v14 offset:36352
    v_mfma_f32_32x32x16_bf16 v[152:167], v[240:243], v[124:127], v[152:167]
    ds_read_b64_tr_b16 v[236:237], v14 offset:35584
    ds_read_b64_tr_b16 v[238:239], v14 offset:36608
    v_mfma_f32_32x32x16_bf16 v[168:183], v[244:247], v[124:127], v[168:183]
    ds_read_b64_tr_b16 v[240:241], v15 offset:38912
    ds_read_b64_tr_b16 v[242:243], v15 offset:39168
    s_waitcnt lgkmcnt(11)
    v_mfma_f32_32x32x16_bf16 v[184:199], v[216:219], v[124:127], v[184:199]
    ds_read_b64_tr_b16 v[244:245], v14 offset:39936
    ds_read_b64_tr_b16 v[246:247], v14 offset:40960
    s_waitcnt lgkmcnt(10)
    v_cmp_gt_u32 vcc, 11, v253
    s_cbranch_vccnz L_SP3
L_SPB3:
    ds_read_b32 v253, v255 offset:48
    v_mfma_f32_32x32x16_bf16 v[200:215], v[220:223], v[124:127], v[200:215]
    ds_read_b64_tr_b16 v[216:217], v14 offset:40192
    ds_read_b64_tr_b16 v[218:219], v14 offset:41216
    s_waitcnt lgkmcnt(9)
    v_mfma_f32_32x32x16_bf16 v[136:151], v[224:227], v[128:131], v[136:151]
    ds_read_b64_tr_b16 v[220:221], v14 offset:40448
    ds_read_b64_tr_b16 v[222:223], v14 offset:41472
    v_mfma_f32_32x32x16_bf16 v[152:167], v[228:231], v[128:131], v[152:167]
    ds_read_b64_tr_b16 v[224:225], v14 offset:40704
    ds_read_b64_tr_b16 v[226:227], v14 offset:41728
    v_mfma_f32_32x32x16_bf16 v[168:183], v[232:235], v[128:131], v[168:183]
    ds_read_b64_tr_b16 v[228:229], v15 offset:44032
    ds_read_b64_tr_b16 v[230:231], v15 offset:44288
    s_waitcnt lgkmcnt(11)
    v_mfma_f32_32x32x16_bf16 v[184:199], v[236:239], v[128:131], v[184:199]
    s_waitcnt lgkmcnt(8)
    v_cmp_gt_u32 vcc, 2, v253
    s_cbranch_vccnz L_SP4
L_SPB4:
    v_mfma_f32_32x32x16_bf16 v[200:215], v[240:243], v[128:131], v[200:215]
    ds_read_b128 v[72:75], v18 offset:0
    ds_read_b32 v253, v252
    s_waitcnt lgkmcnt(6)
    v_mfma_f32_32x32x16_bf16 v[136:151], v[244:247], v[132:135], v[136:151]
    ds_read_b128 v[76:79], v18 offset:1024
    v_mfma_f32_32x32x16_bf16 v[152:167], v[216:219], v[132:135], v[152:167]
    ds_read_b128 v[80:83], v18 offset:2048
    v_mfma_f32_32x32x16_bf16 v[168:183], v[220:223], v[132:135], v[168:183]
    ds_read_b128 v[84:87], v18 offset:3072
    s_waitcnt lgkmcnt(5)
    v_mfma_f32_32x32x16_bf16 v[184:199], v[224:227], v[132:135], v[184:199]
    ds_read_b128 v[88:91], v18 offset:4096
    v_mfma_f32_32x32x16_bf16 v[200:215], v[228:231], v[132:135], v[200:215]
    s_waitcnt lgkmcnt(0)
    v_mfma_f32_32x32x16_bf16 v[136:151], v[72:75], v[20:23], v[136:151]
    v_mfma_f32_32x32x16_bf16 v[152:167], v[76:79], v[20:23], v[152:167]
    v_mfma_f32_32x32x16_bf16 v[168:183], v[80:83], v[20:23], v[168:183]
    v_mfma_f32_32x32x16_bf16 v[184:199], v[84:87], v[20:23], v[184:199]
    v_mfma_f32_32x32x16_bf16 v[200:215], v[88:91], v[20:23], v[200:215]
    s_setprio 2
    v_readfirstlane_b32 s6, v253
    s_mov_b32 s17, 3
    s_cmp_eq_u32 s6, 0
    s_cbranch_scc1 L_NK
    ds_read_b128 v[24:27], v249 offset:0
    ds_read_b128 v[28:31], v249 offset:1024
    ds_read_b128 v[32:35], v249 offset:2048
    ds_read_b128 v[36:39], v249 offset:3072
    ds_read_b128 v[40:43], v249 offset:4096
    ds_read_b128 v[44:47], v249 offset:5120
    ds_read_b128 v[48:51], v249 offset:6144
    ds_read_b128 v[52:55], v249 offset:7168
    ds_read_b128 v[56:59], v250 offset:0
    ds_read_b128 v[60:63], v250 offset:1024
    ds_read_b128 v[64:67], v250 offset:2048
    ds_read_b128 v[68:71], v250 offset:3072
L_NK:
    s_nop 2
    v_pk_mul_f32 v[136:137], v[136:137], v[6:7]
    v_cvt_pk_bf16_f32 v136, v136, v137
    v_pk_max_i16 v136, v136, 0
    v_pk_mul_f32 v[138:139], v[138:139], v[6:7]
    v_cvt_pk_bf16_f32 v137, v138, v139
    v_pk_max_i16 v137, v137, 0
    v_pk_mul_f32 v[140:141], v[140:141], v[6:7]
    v_cvt_pk_bf16_f32 v138, v140, v141
    v_pk_max_i16 v138, v138, 0
    v_pk_mul_f32 v[142:143], v[142:143], v[6:7]
    v_cvt_pk_bf16_f32 v139, v142, v143
    v_pk_max_i16 v139, v139, 0
    v_pk_mul_f32 v[144:145], v[144:145], v[6:7]
    v_cvt_pk_bf16_f32 v140, v144, v145
    v_pk_max_i16 v140, v140, 0
    v_pk_mul_f32 v[146:147], v[146:147], v[6:7]
    v_cvt_pk_bf16_f32 v141, v146, v147
    v_pk_max_i16 v141, v141, 0
    v_pk_mul_f32 v[148:149], v[148:149], v[6:7]
    v_cvt_pk_bf16_f32 v142, v148, v149
    v_pk_max_i16 v142, v142, 0
    v_pk_mul_f32 v[150:151], v[150:151], v[6:7]
    v_cvt_pk_bf16_f32 v143, v150, v151
    v_pk_max_i16 v143, v143, 0
    ds_write_b128 v251, v[136:139] offset:0
    ds_write_b128 v251, v[140:143] offset:1024
    v_pk_mul_f32 v[152:153], v[152:153], v[6:7]
    v_cvt_pk_bf16_f32 v152, v152, v153
    v_pk_max_i16 v152, v152, 0
    v_pk_mul_f32 v[154:155], v[154:155], v[6:7]
    v_cvt_pk_bf16_f32 v153, v154, v155
    v_pk_max_i16 v153, v153, 0
    v_pk_mul_f32 v[156:157], v[156:157], v[6:7]
    v_cvt_pk_bf16_f32 v154, v156, v157
    v_pk_max_i16 v154, v154, 0
    v_pk_mul_f32 v[158:159], v[158:159], v[6:7]
    v_cvt_pk_bf16_f32 v155, v158, v159
    v_pk_max_i16 v155, v155, 0
    v_pk_mul_f32 v[160:161], v[160:161], v[6:7]
    v_cvt_pk_bf16_f32 v156, v160, v161
    v_pk_max_i16 v156, v156, 0
    v_pk_mul_f32 v[162:163], v[162:163], v[6:7]
    v_cvt_pk_bf16_f32 v157, v162, v163
    v_pk_max_i16 v157, v157, 0
    v_pk_mul_f32 v[164:165], v[164:165], v[6:7]
    v_cvt_pk_bf16_f32 v158, v164, v165
    v_pk_max_i16 v158, v158, 0
    v_pk_mul_f32 v[166:167], v[166:167], v[6:7]
    v_cvt_pk_bf16_f32 v159, v166, v167
    v_pk_max_i16 v159, v159, 0
    ds_write_b128 v251, v[152:155] offset:2048
    ds_write_b128 v251, v[156:159] offset:3072
    v_pk_mul_f32 v[168:169], v[168:169], v[6:7]
    v_cvt_pk_bf16_f32 v168, v168, v169
    v_pk_max_i16 v168, v168, 0
    v_pk_mul_f32 v[170:171], v[170:171], v[6:7]
    v_cvt_pk_bf16_f32 v169, v170, v171
    v_pk_max_i16 v169, v169, 0
    v_pk_mul_f32 v[172:173], v[172:173], v[6:7]
    v_cvt_pk_bf16_f32 v170, v172, v173
    v_pk_max_i16 v170, v170, 0
    v_pk_mul_f32 v[174:175], v[174:175], v[6:7]
    v_cvt_pk_bf16_f32 v171, v174, v175
    v_pk_max_i16 v171, v171, 0
    v_pk_mul_f32 v[176:177], v[176:177], v[6:7]
    v_cvt_pk_bf16_f32 v172, v176, v177
    v_pk_max_i16 v172, v172, 0
    v_pk_mul_f32 v[178:179], v[178:179], v[6:7]
    v_cvt_pk_bf16_f32 v173, v178, v179
    v_pk_max_i16 v173, v173, 0
    v_pk_mul_f32 v[180:181], v[180:181], v[6:7]
    v_cvt_pk_bf16_f32 v174, v180, v181
    v_pk_max_i16 v174, v174, 0
    v_pk_mul_f32 v[182:183], v[182:183], v[6:7]
    v_cvt_pk_bf16_f32 v175, v182, v183
    v_pk_max_i16 v175, v175, 0
    ds_write_b128 v251, v[168:171] offset:4096
    ds_write_b128 v251, v[172:175] offset:5120
    v_pk_mul_f32 v[184:185], v[184:185], v[6:7]
    v_cvt_pk_bf16_f32 v184, v184, v185
    v_pk_max_i16 v184, v184, 0
    v_pk_mul_f32 v[186:187], v[186:187], v[6:7]
    v_cvt_pk_bf16_f32 v185, v186, v187
    v_pk_max_i16 v185, v185, 0
    v_pk_mul_f32 v[188:189], v[188:189], v[6:7]
    v_cvt_pk_bf16_f32 v186, v188, v189
    v_pk_max_i16 v186, v186, 0
    v_pk_mul_f32 v[190:191], v[190:191], v[6:7]
    v_cvt_pk_bf16_f32 v187, v190, v191
    v_pk_max_i16 v187, v187, 0
    v_pk_mul_f32 v[192:193], v[192:193], v[6:7]
    v_cvt_pk_bf16_f32 v188, v192, v193
    v_pk_max_i16 v188, v188, 0
    v_pk_mul_f32 v[194:195], v[194:195], v[6:7]
    v_cvt_pk_bf16_f32 v189, v194, v195
    v_pk_max_i16 v189, v189, 0
    v_pk_mul_f32 v[196:197], v[196:197], v[6:7]
    v_cvt_pk_bf16_f32 v190, v196, v197
    v_pk_max_i16 v190, v190, 0
    v_pk_mul_f32 v[198:199], v[198:199], v[6:7]
    v_cvt_pk_bf16_f32 v191, v198, v199
    v_pk_max_i16 v191, v191, 0
    ds_write_b128 v251, v[184:187] offset:6144
    ds_write_b128 v251, v[188:191] offset:7168
    v_mov_b32 v16, 1
    ds_write_b32 v252, v16 offset:16
    v_mul_f32 v6, 0x3e8b97f6, v6
    v_mov_b32 v7, v6
    v_pk_mul_f32 v[200:201], v[200:201], v[6:7]
    v_cvt_pk_bf16_f32 v200, v200, v201
    v_pk_mul_f32 v[202:203], v[202:203], v[6:7]
    v_cvt_pk_bf16_f32 v201, v202, v203
    v_pk_mul_f32 v[204:205], v[204:205], v[6:7]
    v_cvt_pk_bf16_f32 v202, v204, v205
    v_pk_mul_f32 v[206:207], v[206:207], v[6:7]
    v_cvt_pk_bf16_f32 v203, v206, v207
    v_pk_mul_f32 v[208:209], v[208:209], v[6:7]
    v_cvt_pk_bf16_f32 v204, v208, v209
    v_pk_mul_f32 v[210:211], v[210:211], v[6:7]
    v_cvt_pk_bf16_f32 v205, v210, v211
    v_pk_mul_f32 v[212:213], v[212:213], v[6:7]
    v_cvt_pk_bf16_f32 v206, v212, v213
    v_pk_mul_f32 v[214:215], v[214:215], v[6:7]
    v_cvt_pk_bf16_f32 v207, v214, v215
    v_cndmask_b32 v206, v206, 0, s[36:37]
    v_cndmask_b32 v207, v207, 0, s[36:37]
    s_cmp_lg_u32 s6, 0
    s_cbranch_scc1 L_LOADED
    s_mov_b32 s56, 1048576
L_AP:
    ds_read_b32 v253, v252
    s_sub_u32 s56, s56, 1
    s_cbranch_scc1 L_APX
    s_waitcnt lgkmcnt(0)
    v_readfirstlane_b32 s6, v253
    s_cmp_eq_u32 s6, 0
    s_cbranch_scc1 L_AP
L_APX:
    ds_read_b128 v[24:27], v249 offset:0
    ds_read_b128 v[28:31], v249 offset:1024
    ds_read_b128 v[32:35], v249 offset:2048
    ds_read_b128 v[36:39], v249 offset:3072
    ds_read_b128 v[40:43], v249 offset:4096
    ds_read_b128 v[44:47], v249 offset:5120
    ds_read_b128 v[48:51], v249 offset:6144
    ds_read_b128 v[52:55], v249 offset:7168
    ds_read_b128 v[56:59], v250 offset:0
    ds_read_b128 v[60:63], v250 offset:1024
    ds_read_b128 v[64:67], v250 offset:2048
    ds_read_b128 v[68:71], v250 offset:3072
L_LOADED:
    s_waitcnt lgkmcnt(0)
    v_mfma_f32_32x32x16_bf16 v[216:231], v[24:27], v[200:203], 0
    v_mfma_f32_32x32x16_bf16 v[216:231], v[28:31], v[204:207], v[216:231]
    s_add_u32 s33, s28, 1
    s_and_b32 s33, s33, 3
    s_lshl_b32 s33, s33, 13
    s_add_u32 s33, s33, 49152
    v_add_u32 v16, s33, v2
    s_add_u32 s33, s28, 2
    s_and_b32 s33, s33, 3
    s_lshl_b32 s33, s33, 13
    s_add_u32 s33, s33, 49152
    v_add_u32 v17, s33, v2
    s_add_u32 s33, s28, 3
    s_and_b32 s33, s33, 3
    s_lshl_b32 s33, s33, 13
    s_add_u32 s33, s33, 49152
    v_add_u32 v18, s33, v2
    s_add_u32 s33, s28, 4
    s_and_b32 s33, s33, 3
    s_lshl_b32 s33, s33, 13
    s_add_u32 s33, s33, 49152
    v_add_u32 v19, s33, v2
    ds_write_b128 v19, v[200:203]
    v_max3_f32 v208, v216, v217, v218
    v_max3_f32 v209, v219, v220, v221
    v_max3_f32 v208, v222, v223, v208
    v_max3_f32 v209, v224, v225, v209
    v_max3_f32 v208, v226, v227, v208
    v_max3_f32 v209, v228, v229, v209
    v_max3_f32 v208, v230, v231, v208
    v_max_f32 v208, v208, v209
    v_mov_b32 v209, v208
    s_nop 1
    v_permlane32_swap_b32 v208, v209
    v_max_f32 v208, v208, v209
    v_add_f32 v208, 0x42c00000, v208
    v_sub_f32 v208, 0, v208
    v_and_b32 v210, s35, v208
    v_sub_f32 v208, v208, v210
    v_and_b32 v209, s35, v208
    v_sub_f32 v208, v208, v209
    v_lshrrev_b32 v210, 16, v210
    v_or_b32 v210, v210, v209
    v_lshrrev_b32 v211, 16, v208
    v_cndmask_b32 v206, v206, v210, s[36:37]
    v_cndmask_b32 v207, v207, v211, s[36:37]
    ds_write_b128 v19, v[204:207] offset:1024
    v_mov_b32 v12, 153600
    v_mov_b32 v13, 1
    s_add_u32 s21, s21, 4
    s_mov_b64 exec, 1
    ds_add_u32 v12, v13
    s_mov_b64 exec, -1
    s_mov_b32 s56, 131072
L_AS0:
    ds_read_b32 v13, v12
    s_sub_u32 s56, s56, 1
    s_cbranch_scc1 L_ASX0
    s_waitcnt lgkmcnt(0)
    v_readfirstlane_b32 s32, v13
    s_cmp_lt_u32 s32, s21
    s_cbranch_scc1 L_AS0
L_ASX0:
    ds_read_b128 v[88:91], v16 offset:0
    ds_read_b128 v[92:95], v16 offset:1024
    ds_read_b128 v[96:99], v17 offset:0
    ds_read_b128 v[100:103], v17 offset:1024
    ds_read_b128 v[104:107], v18 offset:0
    ds_read_b128 v[108:111], v18 offset:1024
L_GO:
    v_mfma_f32_32x32x16_bf16 v[216:231], v[24:27], v[200:203], 0
    v_mfma_f32_32x32x16_bf16 v[216:231], v[28:31], v[204:207], v[216:231]
    s_waitcnt lgkmcnt(0)
    s_add_u32 s33, s28, 1
    s_and_b32 s33, s33, 3
    s_mul_i32 s33, s33, 12288
    v_add_u32 v16, s33, v2
    s_add_u32 s33, s28, 2
    s_and_b32 s33, s33, 3
    s_mul_i32 s33, s33, 12288
    v_add_u32 v17, s33, v2
    s_add_u32 s33, s28, 3
    s_and_b32 s33, s33, 3
    s_mul_i32 s33, s33, 12288
    v_add_u32 v18, s33, v2
    s_add_u32 s33, s28, 4
    s_and_b32 s33, s33, 3
    s_mul_i32 s33, s33, 12288
    v_add_u32 v19, s33, v2
    v_mfma_f32_32x32x16_bf16 v[232:247], v[24:27], v[88:91], 0
    s_add_u32 s18, s17, s29
    v_exp_f32 v216, v216
    v_exp_f32 v217, v217
    v_exp_f32 v218, v218
    v_mfma_f32_32x32x16_bf16 v[232:247], v[28:31], v[92:95], v[232:247]
    s_and_b32 s18, s18, 15
    v_exp_f32 v219, v219
    v_exp_f32 v220, v220
    v_exp_f32 v221, v221
    s_lshl_b32 s18, s18, 12
    v_exp_f32 v222, v222
    v_exp_f32 v223, v223
    v_cvt_pk_bf16_f32 v120, v216, v217
    v_cvt_pk_bf16_f32 v121, v218, v219
    s_add_u32 s18, s18, s16
    v_exp_f32 v224, v224
    v_exp_f32 v225, v225
    v_exp_f32 v226, v226
    v_exp_f32 v227, v227
    v_exp_f32 v228, v228
    v_exp_f32 v229, v229
    v_exp_f32 v230, v230
    v_exp_f32 v231, v231
    v_cvt_pk_bf16_f32 v122, v220, v221
    v_cvt_pk_bf16_f32 v123, v222, v223
    v_cvt_pk_bf16_f32 v124, v224, v225
    v_cvt_pk_bf16_f32 v125, v226, v227
    v_cvt_pk_bf16_f32 v126, v228, v229
    v_cvt_pk_bf16_f32 v127, v230, v231
    v_mfma_f32_32x32x16_bf16 v[216:231], v[24:27], v[96:99], 0
    v_exp_f32 v232, v232
    v_exp_f32 v233, v233
    v_exp_f32 v234, v234
    v_mfma_f32_32x32x16_bf16 v[216:231], v[28:31], v[100:103], v[216:231]
    s_add_u32 s17, s17, 1
    v_exp_f32 v235, v235
    v_exp_f32 v236, v236
    v_exp_f32 v237, v237
    v_mfma_f32_32x32x16_bf16 v[184:199], v[32:35], v[120:123], 0
    buffer_load_dwordx4 v[72:75], v2, s[8:11], s18 offen offset:0 sc1
    buffer_load_dwordx4 v[76:79], v2, s[8:11], s18 offen offset:1024 sc1
    buffer_load_dwordx4 v[80:83], v2, s[8:11], s18 offen offset:2048 sc1
    buffer_load_dwordx4 v[84:87], v2, s[8:11], s18 offen offset:3072 sc1
    v_exp_f32 v238, v238
    v_exp_f32 v239, v239
    v_cvt_pk_bf16_f32 v128, v232, v233
    v_cvt_pk_bf16_f32 v129, v234, v235
    v_mfma_f32_32x32x16_bf16 v[184:199], v[36:39], v[124:127], v[184:199]
    v_exp_f32 v240, v240
    v_exp_f32 v241, v241
    v_exp_f32 v242, v242
    v_exp_f32 v243, v243
    v_exp_f32 v244, v244
    v_exp_f32 v245, v245
    v_exp_f32 v246, v246
    v_exp_f32 v247, v247
    v_cvt_pk_bf16_f32 v130, v236, v237
    v_cvt_pk_bf16_f32 v131, v238, v239
    v_cvt_pk_bf16_f32 v132, v240, v241
    v_cvt_pk_bf16_f32 v133, v242, v243
    v_cvt_pk_bf16_f32 v134, v244, v245
    v_cvt_pk_bf16_f32 v135, v246, v247
    v_mfma_f32_32x32x16_bf16 v[232:247], v[24:27], v[104:107], 0
    v_exp_f32 v216, v216
    v_exp_f32 v217, v217
    v_exp_f32 v218, v218
    v_mfma_f32_32x32x16_bf16 v[232:247], v[28:31], v[108:111], v[232:247]
    v_exp_f32 v219, v219
    v_exp_f32 v220, v220
    v_exp_f32 v221, v221
    v_mfma_f32_32x32x16_bf16 v[136:151], v[32:35], v[128:131], 0
    v_exp_f32 v222, v222
    v_exp_f32 v223, v223
    v_cvt_pk_bf16_f32 v120, v216, v217
    v_cvt_pk_bf16_f32 v121, v218, v219
    v_mfma_f32_32x32x16_bf16 v[136:151], v[36:39], v[132:135], v[136:151]
    v_exp_f32 v224, v224
    v_exp_f32 v225, v225
    v_exp_f32 v226, v226
    v_exp_f32 v227, v227
    v_exp_f32 v228, v228
    v_exp_f32 v229, v229
    v_exp_f32 v230, v230
    v_exp_f32 v231, v231
    v_cvt_pk_bf16_f32 v122, v220, v221
    v_cvt_pk_bf16_f32 v123, v222, v223
    v_cvt_pk_bf16_f32 v124, v224, v225
    v_cvt_pk_bf16_f32 v125, v226, v227
    v_cvt_pk_bf16_f32 v126, v228, v229
    v_cvt_pk_bf16_f32 v127, v230, v231
    v_mfma_f32_32x32x16_bf16 v[216:231], v[40:43], v[88:91], 0
    v_exp_f32 v232, v232
    v_exp_f32 v233, v233
    v_exp_f32 v234, v234
    v_mfma_f32_32x32x16_bf16 v[216:231], v[44:47], v[92:95], v[216:231]
    v_exp_f32 v235, v235
    v_exp_f32 v236, v236
    v_exp_f32 v237, v237
    v_mfma_f32_32x32x16_bf16 v[152:167], v[32:35], v[120:123], 0
    v_exp_f32 v238, v238
    v_exp_f32 v239, v239
    v_cvt_pk_bf16_f32 v128, v232, v233
    v_cvt_pk_bf16_f32 v129, v234, v235
    v_mfma_f32_32x32x16_bf16 v[152:167], v[36:39], v[124:127], v[152:167]
    v_exp_f32 v240, v240
    v_exp_f32 v241, v241
    v_exp_f32 v242, v242
    v_exp_f32 v243, v243
    v_exp_f32 v244, v244
    v_exp_f32 v245, v245
    v_exp_f32 v246, v246
    v_exp_f32 v247, v247
    v_cvt_pk_bf16_f32 v130, v236, v237
    v_cvt_pk_bf16_f32 v131, v238, v239
    v_cvt_pk_bf16_f32 v132, v240, v241
    v_cvt_pk_bf16_f32 v133, v242, v243
    v_cvt_pk_bf16_f32 v134, v244, v245
    v_cvt_pk_bf16_f32 v135, v246, v247
    v_mfma_f32_32x32x16_bf16 v[232:247], v[40:43], v[96:99], 0
    s_add_u32 s18, s17, s29
    v_exp_f32 v216, v216
    v_exp_f32 v217, v217
    v_exp_f32 v218, v218
    v_mfma_f32_32x32x16_bf16 v[232:247], v[44:47], v[100:103], v[232:247]
    s_and_b32 s18, s18, 15
    v_exp_f32 v219, v219
    v_exp_f32 v220, v220
    v_exp_f32 v221, v221
    v_mfma_f32_32x32x16_bf16 v[168:183], v[32:35], v[128:131], 0
    s_lshl_b32 s18, s18, 12
    v_exp_f32 v222, v222
    v_exp_f32 v223, v223
    v_cvt_pk_bf16_f32 v120, v216, v217
    v_cvt_pk_bf16_f32 v121, v218, v219
    v_mfma_f32_32x32x16_bf16 v[168:183], v[36:39], v[132:135], v[168:183]
    s_add_u32 s18, s18, s16
    v_exp_f32 v224, v224
    v_exp_f32 v225, v225
    v_exp_f32 v226, v226
    v_exp_f32 v227, v227
    v_exp_f32 v228, v228
    v_exp_f32 v229, v229
    v_exp_f32 v230, v230
    v_exp_f32 v231, v231
    v_cvt_pk_bf16_f32 v122, v220, v221
    v_cvt_pk_bf16_f32 v123, v222, v223
    v_cvt_pk_bf16_f32 v124, v224, v225
    v_cvt_pk_bf16_f32 v125, v226, v227
    v_cvt_pk_bf16_f32 v126, v228, v229
    v_cvt_pk_bf16_f32 v127, v230, v231
    v_mfma_f32_32x32x16_bf16 v[216:231], v[40:43], v[104:107], 0
    v_exp_f32 v232, v232
    v_exp_f32 v233, v233
    v_exp_f32 v234, v234
    v_mfma_f32_32x32x16_bf16 v[216:231], v[44:47], v[108:111], v[216:231]
    s_add_u32 s17, s17, 1
    v_exp_f32 v235, v235
    v_exp_f32 v236, v236
    v_exp_f32 v237, v237
    v_mfma_f32_32x32x16_bf16 v[136:151], v[48:51], v[120:123], v[136:151]
    buffer_load_dwordx4 v[24:27], v2, s[8:11], s18 offen offset:0 sc1
    buffer_load_dwordx4 v[28:31], v2, s[8:11], s18 offen offset:1024 sc1
    buffer_load_dwordx4 v[32:35], v2, s[8:11], s18 offen offset:2048 sc1
    buffer_load_dwordx4 v[36:39], v2, s[8:11], s18 offen offset:3072 sc1
    v_exp_f32 v238, v238
    v_exp_f32 v239, v239
    v_cvt_pk_bf16_f32 v128, v232, v233
    v_cvt_pk_bf16_f32 v129, v234, v235
    v_mfma_f32_32x32x16_bf16 v[136:151], v[52:55], v[124:127], v[136:151]
    v_exp_f32 v240, v240
    v_exp_f32 v241, v241
    v_exp_f32 v242, v242
    v_exp_f32 v243, v243
    v_exp_f32 v244, v244
    v_exp_f32 v245, v245
    v_exp_f32 v246, v246
    v_exp_f32 v247, v247
    v_cvt_pk_bf16_f32 v130, v236, v237
    v_cvt_pk_bf16_f32 v131, v238, v239
    v_cvt_pk_bf16_f32 v132, v240, v241
    v_cvt_pk_bf16_f32 v133, v242, v243
    v_cvt_pk_bf16_f32 v134, v244, v245
    v_cvt_pk_bf16_f32 v135, v246, v247
    v_mfma_f32_32x32x16_bf16 v[232:247], v[40:43], v[200:203], 0
    v_exp_f32 v216, v216
    v_exp_f32 v217, v217
    v_exp_f32 v218, v218
    v_mfma_f32_32x32x16_bf16 v[232:247], v[44:47], v[204:207], v[232:247]
    v_exp_f32 v219, v219
    v_exp_f32 v220, v220
    v_exp_f32 v221, v221
    v_mfma_f32_32x32x16_bf16 v[152:167], v[48:51], v[128:131], v[152:167]
    v_exp_f32 v222, v222
    v_exp_f32 v223, v223
    v_cvt_pk_bf16_f32 v120, v216, v217
    v_cvt_pk_bf16_f32 v121, v218, v219
    v_mfma_f32_32x32x16_bf16 v[152:167], v[52:55], v[132:135], v[152:167]
    v_exp_f32 v224, v224
    v_exp_f32 v225, v225
    v_exp_f32 v226, v226
    v_exp_f32 v227, v227
    v_exp_f32 v228, v228
    v_exp_f32 v229, v229
    v_exp_f32 v230, v230
    v_exp_f32 v231, v231
    v_cvt_pk_bf16_f32 v122, v220, v221
    v_cvt_pk_bf16_f32 v123, v222, v223
    v_cvt_pk_bf16_f32 v124, v224, v225
    v_cvt_pk_bf16_f32 v125, v226, v227
    v_cvt_pk_bf16_f32 v126, v228, v229
    v_cvt_pk_bf16_f32 v127, v230, v231
    v_mfma_f32_32x32x16_bf16 v[216:231], v[56:59], v[88:91], 0
    v_exp_f32 v232, v232
    v_exp_f32 v233, v233
    v_exp_f32 v234, v234
    v_mfma_f32_32x32x16_bf16 v[216:231], v[60:63], v[92:95], v[216:231]
    v_exp_f32 v235, v235
    v_exp_f32 v236, v236
    v_exp_f32 v237, v237
    v_mfma_f32_32x32x16_bf16 v[168:183], v[48:51], v[120:123], v[168:183]
    v_exp_f32 v238, v238
    v_exp_f32 v239, v239
    v_cvt_pk_bf16_f32 v128, v232, v233
    v_cvt_pk_bf16_f32 v129, v234, v235
    v_mfma_f32_32x32x16_bf16 v[168:183], v[52:55], v[124:127], v[168:183]
    v_exp_f32 v240, v240
    v_exp_f32 v241, v241
    v_exp_f32 v242, v242
    v_exp_f32 v243, v243
    v_exp_f32 v244, v244
    v_exp_f32 v245, v245
    v_exp_f32 v246, v246
    v_exp_f32 v247, v247
    v_cvt_pk_bf16_f32 v130, v236, v237
    v_cvt_pk_bf16_f32 v131, v238, v239
    v_cvt_pk_bf16_f32 v132, v240, v241
    v_cvt_pk_bf16_f32 v133, v242, v243
    v_cvt_pk_bf16_f32 v134, v244, v245
    v_cvt_pk_bf16_f32 v135, v246, v247
    v_mfma_f32_32x32x16_bf16 v[232:247], v[56:59], v[96:99], 0
    s_add_u32 s18, s17, s29
    v_exp_f32 v216, v216
    v_exp_f32 v217, v217
    v_exp_f32 v218, v218
    v_mfma_f32_32x32x16_bf16 v[232:247], v[60:63], v[100:103], v[232:247]
    s_and_b32 s18, s18, 15
    v_exp_f32 v219, v219
    v_exp_f32 v220, v220
    v_exp_f32 v221, v221
    v_mfma_f32_32x32x16_bf16 v[184:199], v[48:51], v[128:131], v[184:199]
    s_lshl_b32 s18, s18, 12
    v_exp_f32 v222, v222
    v_exp_f32 v223, v223
    v_cvt_pk_bf16_f32 v120, v216, v217
    v_cvt_pk_bf16_f32 v121, v218, v219
    v_mfma_f32_32x32x16_bf16 v[184:199], v[52:55], v[132:135], v[184:199]
    s_add_u32 s18, s18, s16
    v_exp_f32 v224, v224
    v_exp_f32 v225, v225
    v_exp_f32 v226, v226
    v_exp_f32 v227, v227
    v_exp_f32 v228, v228
    v_exp_f32 v229, v229
    v_exp_f32 v230, v230
    v_exp_f32 v231, v231
    v_cvt_pk_bf16_f32 v122, v220, v221
    v_cvt_pk_bf16_f32 v123, v222, v223
    v_cvt_pk_bf16_f32 v124, v224, v225
    v_cvt_pk_bf16_f32 v125, v226, v227
    v_cvt_pk_bf16_f32 v126, v228, v229
    v_cvt_pk_bf16_f32 v127, v230, v231
    v_mfma_f32_32x32x16_bf16 v[216:231], v[56:59], v[104:107], 0
    v_exp_f32 v232, v232
    v_exp_f32 v233, v233
    v_exp_f32 v234, v234
    v_mfma_f32_32x32x16_bf16 v[216:231], v[60:63], v[108:111], v[216:231]
    s_add_u32 s17, s17, 1
    v_exp_f32 v235, v235
    v_exp_f32 v236, v236
    v_exp_f32 v237, v237
    v_mfma_f32_32x32x16_bf16 v[136:151], v[64:67], v[120:123], v[136:151]
    buffer_load_dwordx4 v[40:43], v2, s[8:11], s18 offen offset:0 sc1
    buffer_load_dwordx4 v[44:47], v2, s[8:11], s18 offen offset:1024 sc1
    buffer_load_dwordx4 v[48:51], v2, s[8:11], s18 offen offset:2048 sc1
    buffer_load_dwordx4 v[52:55], v2, s[8:11], s18 offen offset:3072 sc1
    v_exp_f32 v238, v238
    v_exp_f32 v239, v239
    v_cvt_pk_bf16_f32 v128, v232, v233
    v_cvt_pk_bf16_f32 v129, v234, v235
    v_mfma_f32_32x32x16_bf16 v[136:151], v[68:71], v[124:127], v[136:151]
    v_exp_f32 v240, v240
    v_exp_f32 v241, v241
    v_exp_f32 v242, v242
    v_exp_f32 v243, v243
    v_exp_f32 v244, v244
    v_exp_f32 v245, v245
    v_exp_f32 v246, v246
    v_exp_f32 v247, v247
    v_cvt_pk_bf16_f32 v130, v236, v237
    v_cvt_pk_bf16_f32 v131, v238, v239
    v_cvt_pk_bf16_f32 v132, v240, v241
    v_cvt_pk_bf16_f32 v133, v242, v243
    v_cvt_pk_bf16_f32 v134, v244, v245
    v_cvt_pk_bf16_f32 v135, v246, v247
    v_mfma_f32_32x32x16_bf16 v[232:247], v[56:59], v[200:203], 0
    v_exp_f32 v216, v216
    v_exp_f32 v217, v217
    v_exp_f32 v218, v218
    v_mfma_f32_32x32x16_bf16 v[232:247], v[60:63], v[204:207], v[232:247]
    v_exp_f32 v219, v219
    v_exp_f32 v220, v220
    v_exp_f32 v221, v221
    v_mfma_f32_32x32x16_bf16 v[152:167], v[64:67], v[128:131], v[152:167]
    v_exp_f32 v222, v222
    v_exp_f32 v223, v223
    v_cvt_pk_bf16_f32 v120, v216, v217
    v_cvt_pk_bf16_f32 v121, v218, v219
    v_mfma_f32_32x32x16_bf16 v[152:167], v[68:71], v[132:135], v[152:167]
    s_waitcnt vmcnt(8)
    v_exp_f32 v224, v224
    v_exp_f32 v225, v225
    v_exp_f32 v226, v226
    v_exp_f32 v227, v227
    v_exp_f32 v228, v228
    v_exp_f32 v229, v229
    v_exp_f32 v230, v230
    v_exp_f32 v231, v231
    v_cvt_pk_bf16_f32 v122, v220, v221
    v_cvt_pk_bf16_f32 v123, v222, v223
    v_cvt_pk_bf16_f32 v124, v224, v225
    v_cvt_pk_bf16_f32 v125, v226, v227
    v_cvt_pk_bf16_f32 v126, v228, v229
    v_cvt_pk_bf16_f32 v127, v230, v231
    v_mfma_f32_32x32x16_bf16 v[216:231], v[72:75], v[88:91], 0
    v_exp_f32 v232, v232
    v_exp_f32 v233, v233
    v_exp_f32 v234, v234
    v_mfma_f32_32x32x16_bf16 v[216:231], v[76:79], v[92:95], v[216:231]
    v_exp_f32 v235, v235
    v_exp_f32 v236, v236
    v_exp_f32 v237, v237
    v_mfma_f32_32x32x16_bf16 v[168:183], v[64:67], v[120:123], v[168:183]
    v_exp_f32 v238, v238
    v_exp_f32 v239, v239
    v_cvt_pk_bf16_f32 v128, v232, v233
    v_cvt_pk_bf16_f32 v129, v234, v235
    v_mfma_f32_32x32x16_bf16 v[168:183], v[68:71], v[124:127], v[168:183]
    v_exp_f32 v240, v240
    v_exp_f32 v241, v241
    v_exp_f32 v242, v242
    v_exp_f32 v243, v243
    v_exp_f32 v244, v244
    v_exp_f32 v245, v245
    v_exp_f32 v246, v246
    v_exp_f32 v247, v247
    v_cvt_pk_bf16_f32 v130, v236, v237
    v_cvt_pk_bf16_f32 v131, v238, v239
    v_cvt_pk_bf16_f32 v132, v240, v241
    v_cvt_pk_bf16_f32 v133, v242, v243
    v_cvt_pk_bf16_f32 v134, v244, v245
    v_cvt_pk_bf16_f32 v135, v246, v247
    v_mfma_f32_32x32x16_bf16 v[232:247], v[72:75], v[96:99], 0
    s_add_u32 s18, s17, s29
    v_exp_f32 v216, v216
    v_exp_f32 v217, v217
    v_exp_f32 v218, v218
    v_mfma_f32_32x32x16_bf16 v[232:247], v[76:79], v[100:103], v[232:247]
    s_and_b32 s18, s18, 15
    v_exp_f32 v219, v219
    v_exp_f32 v220, v220
    v_exp_f32 v221, v221
    v_mfma_f32_32x32x16_bf16 v[184:199], v[64:67], v[128:131], v[184:199]
    s_lshl_b32 s18, s18, 12
    v_exp_f32 v222, v222
    v_exp_f32 v223, v223
    v_cvt_pk_bf16_f32 v120, v216, v217
    v_cvt_pk_bf16_f32 v121, v218, v219
    v_mfma_f32_32x32x16_bf16 v[184:199], v[68:71], v[132:135], v[184:199]
    s_add_u32 s18, s18, s16
    v_exp_f32 v224, v224
    v_exp_f32 v225, v225
    v_exp_f32 v226, v226
    v_exp_f32 v227, v227
    v_exp_f32 v228, v228
    v_exp_f32 v229, v229
    v_exp_f32 v230, v230
    v_exp_f32 v231, v231
    v_cvt_pk_bf16_f32 v122, v220, v221
    v_cvt_pk_bf16_f32 v123, v222, v223
    v_cvt_pk_bf16_f32 v124, v224, v225
    v_cvt_pk_bf16_f32 v125, v226, v227
    v_cvt_pk_bf16_f32 v126, v228, v229
    v_cvt_pk_bf16_f32 v127, v230, v231
    v_mfma_f32_32x32x16_bf16 v[216:231], v[72:75], v[104:107], 0
    v_exp_f32 v232, v232
    v_exp_f32 v233, v233
    v_exp_f32 v234, v234
    v_mfma_f32_32x32x16_bf16 v[216:231], v[76:79], v[108:111], v[216:231]
    s_add_u32 s17, s17, 1
    v_exp_f32 v235, v235
    v_exp_f32 v236, v236
    v_exp_f32 v237, v237
    v_mfma_f32_32x32x16_bf16 v[136:151], v[80:83], v[120:123], v[136:151]
    buffer_load_dwordx4 v[56:59], v2, s[8:11], s18 offen offset:0 sc1
    buffer_load_dwordx4 v[60:63], v2, s[8:11], s18 offen offset:1024 sc1
    buffer_load_dwordx4 v[64:67], v2, s[8:11], s18 offen offset:2048 sc1
    buffer_load_dwordx4 v[68:71], v2, s[8:11], s18 offen offset:3072 sc1
    v_exp_f32 v238, v238
    v_exp_f32 v239, v239
    v_cvt_pk_bf16_f32 v128, v232, v233
    v_cvt_pk_bf16_f32 v129, v234, v235
    v_mfma_f32_32x32x16_bf16 v[136:151], v[84:87], v[124:127], v[136:151]
    v_exp_f32 v240, v240
    v_exp_f32 v241, v241
    v_exp_f32 v242, v242
    v_exp_f32 v243, v243
    v_exp_f32 v244, v244
    v_exp_f32 v245, v245
    v_exp_f32 v246, v246
    v_exp_f32 v247, v247
    v_cvt_pk_bf16_f32 v130, v236, v237
    v_cvt_pk_bf16_f32 v131, v238, v239
    v_cvt_pk_bf16_f32 v132, v240, v241
    v_cvt_pk_bf16_f32 v133, v242, v243
    v_cvt_pk_bf16_f32 v134, v244, v245
    v_cvt_pk_bf16_f32 v135, v246, v247
    v_mfma_f32_32x32x16_bf16 v[232:247], v[72:75], v[200:203], 0
    v_exp_f32 v216, v216
    v_exp_f32 v217, v217
    v_exp_f32 v218, v218
    v_mfma_f32_32x32x16_bf16 v[232:247], v[76:79], v[204:207], v[232:247]
    v_exp_f32 v219, v219
    v_exp_f32 v220, v220
    v_exp_f32 v221, v221
    v_mfma_f32_32x32x16_bf16 v[152:167], v[80:83], v[128:131], v[152:167]
    v_exp_f32 v222, v222
    v_exp_f32 v223, v223
    v_cvt_pk_bf16_f32 v120, v216, v217
    v_cvt_pk_bf16_f32 v121, v218, v219
    v_mfma_f32_32x32x16_bf16 v[152:167], v[84:87], v[132:135], v[152:167]
    s_waitcnt vmcnt(8)
    v_exp_f32 v224, v224
    v_exp_f32 v225, v225
    v_exp_f32 v226, v226
    v_exp_f32 v227, v227
    v_exp_f32 v228, v228
    v_exp_f32 v229, v229
    v_exp_f32 v230, v230
    v_exp_f32 v231, v231
    v_cvt_pk_bf16_f32 v122, v220, v221
    v_cvt_pk_bf16_f32 v123, v222, v223
    v_cvt_pk_bf16_f32 v124, v224, v225
    v_cvt_pk_bf16_f32 v125, v226, v227
    v_cvt_pk_bf16_f32 v126, v228, v229
    v_cvt_pk_bf16_f32 v127, v230, v231
    v_mfma_f32_32x32x16_bf16 v[216:231], v[24:27], v[88:91], 0
    v_exp_f32 v232, v232
    v_exp_f32 v233, v233
    v_exp_f32 v234, v234
    v_mfma_f32_32x32x16_bf16 v[216:231], v[28:31], v[92:95], v[216:231]
    v_exp_f32 v235, v235
    v_exp_f32 v236, v236
    v_exp_f32 v237, v237
    v_mfma_f32_32x32x16_bf16 v[168:183], v[80:83], v[120:123], v[168:183]
    v_exp_f32 v238, v238
    v_exp_f32 v239, v239
    v_cvt_pk_bf16_f32 v128, v232, v233
    v_cvt_pk_bf16_f32 v129, v234, v235
    v_mfma_f32_32x32x16_bf16 v[168:183], v[84:87], v[124:127], v[168:183]
    v_exp_f32 v240, v240
    v_exp_f32 v241, v241
    v_exp_f32 v242, v242
    v_exp_f32 v243, v243
    v_exp_f32 v244, v244
    v_exp_f32 v245, v245
    v_exp_f32 v246, v246
    v_exp_f32 v247, v247
    v_cvt_pk_bf16_f32 v130, v236, v237
    v_cvt_pk_bf16_f32 v131, v238, v239
    v_cvt_pk_bf16_f32 v132, v240, v241
    v_cvt_pk_bf16_f32 v133, v242, v243
    v_cvt_pk_bf16_f32 v134, v244, v245
    v_cvt_pk_bf16_f32 v135, v246, v247
    s_mov_b32 s20, 2
L_LOOP:
    v_mfma_f32_32x32x16_bf16 v[232:247], v[24:27], v[96:99], 0
    s_add_u32 s18, s17, s29
    v_exp_f32 v216, v216
    v_exp_f32 v217, v217
    v_exp_f32 v218, v218
    v_mfma_f32_32x32x16_bf16 v[232:247], v[28:31], v[100:103], v[232:247]
    s_and_b32 s18, s18, 15
    v_exp_f32 v219, v219
    v_exp_f32 v220, v220
    v_exp_f32 v221, v221
    v_mfma_f32_32x32x16_bf16 v[184:199], v[80:83], v[128:131], v[184:199]
    s_lshl_b32 s18, s18, 12
    v_exp_f32 v222, v222
    v_exp_f32 v223, v223
    v_cvt_pk_bf16_f32 v120, v216, v217
    v_cvt_pk_bf16_f32 v121, v218, v219
    v_mfma_f32_32x32x16_bf16 v[184:199], v[84:87], v[132:135], v[184:199]
    s_add_u32 s18, s18, s16
    v_exp_f32 v224, v224
    v_exp_f32 v225, v225
    v_exp_f32 v226, v226
    v_exp_f32 v227, v227
    v_exp_f32 v228, v228
    v_exp_f32 v229, v229
    v_exp_f32 v230, v230
    v_exp_f32 v231, v231
    v_cvt_pk_bf16_f32 v122, v220, v221
    v_cvt_pk_bf16_f32 v123, v222, v223
    v_cvt_pk_bf16_f32 v124, v224, v225
    v_cvt_pk_bf16_f32 v125, v226, v227
    v_cvt_pk_bf16_f32 v126, v228, v229
    v_cvt_pk_bf16_f32 v127, v230, v231
    v_mfma_f32_32x32x16_bf16 v[216:231], v[24:27], v[104:107], 0
    v_exp_f32 v232, v232
    v_exp_f32 v233, v233
    v_exp_f32 v234, v234
    v_mfma_f32_32x32x16_bf16 v[216:231], v[28:31], v[108:111], v[216:231]
    s_add_u32 s17, s17, 1
    v_exp_f32 v235, v235
    v_exp_f32 v236, v236
    v_exp_f32 v237, v237
    v_mfma_f32_32x32x16_bf16 v[136:151], v[32:35], v[120:123], v[136:151]
    buffer_load_dwordx4 v[72:75], v2, s[8:11], s18 offen offset:0 sc1
    buffer_load_dwordx4 v[76:79], v2, s[8:11], s18 offen offset:1024 sc1
    buffer_load_dwordx4 v[80:83], v2, s[8:11], s18 offen offset:2048 sc1
    buffer_load_dwordx4 v[84:87], v2, s[8:11], s18 offen offset:3072 sc1
    v_exp_f32 v238, v238
    v_exp_f32 v239, v239
    v_cvt_pk_bf16_f32 v128, v232, v233
    v_cvt_pk_bf16_f32 v129, v234, v235
    v_mfma_f32_32x32x16_bf16 v[136:151], v[36:39], v[124:127], v[136:151]
    v_exp_f32 v240, v240
    v_exp_f32 v241, v241
    v_exp_f32 v242, v242
    v_exp_f32 v243, v243
    v_exp_f32 v244, v244
    v_exp_f32 v245, v245
    v_exp_f32 v246, v246
    v_exp_f32 v247, v247
    v_cvt_pk_bf16_f32 v130, v236, v237
    v_cvt_pk_bf16_f32 v131, v238, v239
    v_cvt_pk_bf16_f32 v132, v240, v241
    v_cvt_pk_bf16_f32 v133, v242, v243
    v_cvt_pk_bf16_f32 v134, v244, v245
    v_cvt_pk_bf16_f32 v135, v246, v247
    v_mfma_f32_32x32x16_bf16 v[232:247], v[24:27], v[200:203], 0
    v_exp_f32 v216, v216
    v_exp_f32 v217, v217
    v_exp_f32 v218, v218
    v_mfma_f32_32x32x16_bf16 v[232:247], v[28:31], v[204:207], v[232:247]
    v_exp_f32 v219, v219
    v_exp_f32 v220, v220
    v_exp_f32 v221, v221
    v_mfma_f32_32x32x16_bf16 v[152:167], v[32:35], v[128:131], v[152:167]
    v_exp_f32 v222, v222
    v_exp_f32 v223, v223
    v_cvt_pk_bf16_f32 v120, v216, v217
    v_cvt_pk_bf16_f32 v121, v218, v219
    v_mfma_f32_32x32x16_bf16 v[152:167], v[36:39], v[132:135], v[152:167]
    s_waitcnt vmcnt(8)
    v_exp_f32 v224, v224
    v_exp_f32 v225, v225
    v_exp_f32 v226, v226
    v_exp_f32 v227, v227
    v_exp_f32 v228, v228
    v_exp_f32 v229, v229
    v_exp_f32 v230, v230
    v_exp_f32 v231, v231
    v_cvt_pk_bf16_f32 v122, v220, v221
    v_cvt_pk_bf16_f32 v123, v222, v223
    v_cvt_pk_bf16_f32 v124, v224, v225
    v_cvt_pk_bf16_f32 v125, v226, v227
    v_cvt_pk_bf16_f32 v126, v228, v229
    v_cvt_pk_bf16_f32 v127, v230, v231
    v_mfma_f32_32x32x16_bf16 v[216:231], v[40:43], v[88:91], 0
    v_exp_f32 v232, v232
    v_exp_f32 v233, v233
    v_exp_f32 v234, v234
    v_mfma_f32_32x32x16_bf16 v[216:231], v[44:47], v[92:95], v[216:231]
    v_exp_f32 v235, v235
    v_exp_f32 v236, v236
    v_exp_f32 v237, v237
    v_mfma_f32_32x32x16_bf16 v[168:183], v[32:35], v[120:123], v[168:183]
    v_exp_f32 v238, v238
    v_exp_f32 v239, v239
    v_cvt_pk_bf16_f32 v128, v232, v233
    v_cvt_pk_bf16_f32 v129, v234, v235
    v_mfma_f32_32x32x16_bf16 v[168:183], v[36:39], v[124:127], v[168:183]
    v_exp_f32 v240, v240
    v_exp_f32 v241, v241
    v_exp_f32 v242, v242
    v_exp_f32 v243, v243
    v_exp_f32 v244, v244
    v_exp_f32 v245, v245
    v_exp_f32 v246, v246
    v_exp_f32 v247, v247
    v_cvt_pk_bf16_f32 v130, v236, v237
    v_cvt_pk_bf16_f32 v131, v238, v239
    v_cvt_pk_bf16_f32 v132, v240, v241
    v_cvt_pk_bf16_f32 v133, v242, v243
    v_cvt_pk_bf16_f32 v134, v244, v245
    v_cvt_pk_bf16_f32 v135, v246, v247
    v_mfma_f32_32x32x16_bf16 v[232:247], v[40:43], v[96:99], 0
    s_add_u32 s18, s17, s29
    v_exp_f32 v216, v216
    v_exp_f32 v217, v217
    v_exp_f32 v218, v218
    v_mfma_f32_32x32x16_bf16 v[232:247], v[44:47], v[100:103], v[232:247]
    s_and_b32 s18, s18, 15
    v_exp_f32 v219, v219
    v_exp_f32 v220, v220
    v_exp_f32 v221, v221
    v_mfma_f32_32x32x16_bf16 v[184:199], v[32:35], v[128:131], v[184:199]
    s_lshl_b32 s18, s18, 12
    v_exp_f32 v222, v222
    v_exp_f32 v223, v223
    v_cvt_pk_bf16_f32 v120, v216, v217
    v_cvt_pk_bf16_f32 v121, v218, v219
    v_mfma_f32_32x32x16_bf16 v[184:199], v[36:39], v[132:135], v[184:199]
    s_add_u32 s18, s18, s16
    v_exp_f32 v224, v224
    v_exp_f32 v225, v225
    v_exp_f32 v226, v226
    v_exp_f32 v227, v227
    v_exp_f32 v228, v228
    v_exp_f32 v229, v229
    v_exp_f32 v230, v230
    v_exp_f32 v231, v231
    v_cvt_pk_bf16_f32 v122, v220, v221
    v_cvt_pk_bf16_f32 v123, v222, v223
    v_cvt_pk_bf16_f32 v124, v224, v225
    v_cvt_pk_bf16_f32 v125, v226, v227
    v_cvt_pk_bf16_f32 v126, v228, v229
    v_cvt_pk_bf16_f32 v127, v230, v231
    v_mfma_f32_32x32x16_bf16 v[216:231], v[40:43], v[104:107], 0
    v_exp_f32 v232, v232
    v_exp_f32 v233, v233
    v_exp_f32 v234, v234
    v_mfma_f32_32x32x16_bf16 v[216:231], v[44:47], v[108:111], v[216:231]
    s_add_u32 s17, s17, 1
    v_exp_f32 v235, v235
    v_exp_f32 v236, v236
    v_exp_f32 v237, v237
    v_mfma_f32_32x32x16_bf16 v[136:151], v[48:51], v[120:123], v[136:151]
    buffer_load_dwordx4 v[24:27], v2, s[8:11], s18 offen offset:0 sc1
    buffer_load_dwordx4 v[28:31], v2, s[8:11], s18 offen offset:1024 sc1
    buffer_load_dwordx4 v[32:35], v2, s[8:11], s18 offen offset:2048 sc1
    buffer_load_dwordx4 v[36:39], v2, s[8:11], s18 offen offset:3072 sc1
    v_exp_f32 v238, v238
    v_exp_f32 v239, v239
    v_cvt_pk_bf16_f32 v128, v232, v233
    v_cvt_pk_bf16_f32 v129, v234, v235
    v_mfma_f32_32x32x16_bf16 v[136:151], v[52:55], v[124:127], v[136:151]
    v_exp_f32 v240, v240
    v_exp_f32 v241, v241
    v_exp_f32 v242, v242
    v_exp_f32 v243, v243
    v_exp_f32 v244, v244
    v_exp_f32 v245, v245
    v_exp_f32 v246, v246
    v_exp_f32 v247, v247
    v_cvt_pk_bf16_f32 v130, v236, v237
    v_cvt_pk_bf16_f32 v131, v238, v239
    v_cvt_pk_bf16_f32 v132, v240, v241
    v_cvt_pk_bf16_f32 v133, v242, v243
    v_cvt_pk_bf16_f32 v134, v244, v245
    v_cvt_pk_bf16_f32 v135, v246, v247
    v_mfma_f32_32x32x16_bf16 v[232:247], v[40:43], v[200:203], 0
    v_exp_f32 v216, v216
    v_exp_f32 v217, v217
    v_exp_f32 v218, v218
    v_mfma_f32_32x32x16_bf16 v[232:247], v[44:47], v[204:207], v[232:247]
    v_exp_f32 v219, v219
    v_exp_f32 v220, v220
    v_exp_f32 v221, v221
    v_mfma_f32_32x32x16_bf16 v[152:167], v[48:51], v[128:131], v[152:167]
    v_exp_f32 v222, v222
    v_exp_f32 v223, v223
    v_cvt_pk_bf16_f32 v120, v216, v217
    v_cvt_pk_bf16_f32 v121, v218, v219
    v_mfma_f32_32x32x16_bf16 v[152:167], v[52:55], v[132:135], v[152:167]
    s_waitcnt vmcnt(8)
    v_exp_f32 v224, v224
    v_exp_f32 v225, v225
    v_exp_f32 v226, v226
    v_exp_f32 v227, v227
    v_exp_f32 v228, v228
    v_exp_f32 v229, v229
    v_exp_f32 v230, v230
    v_exp_f32 v231, v231
    v_cvt_pk_bf16_f32 v122, v220, v221
    v_cvt_pk_bf16_f32 v123, v222, v223
    v_cvt_pk_bf16_f32 v124, v224, v225
    v_cvt_pk_bf16_f32 v125, v226, v227
    v_cvt_pk_bf16_f32 v126, v228, v229
    v_cvt_pk_bf16_f32 v127, v230, v231
    v_mfma_f32_32x32x16_bf16 v[216:231], v[56:59], v[88:91], 0
    v_exp_f32 v232, v232
    v_exp_f32 v233, v233
    v_exp_f32 v234, v234
    v_mfma_f32_32x32x16_bf16 v[216:231], v[60:63], v[92:95], v[216:231]
    v_exp_f32 v235, v235
    v_exp_f32 v236, v236
    v_exp_f32 v237, v237
    v_mfma_f32_32x32x16_bf16 v[168:183], v[48:51], v[120:123], v[168:183]
    v_exp_f32 v238, v238
    v_exp_f32 v239, v239
    v_cvt_pk_bf16_f32 v128, v232, v233
    v_cvt_pk_bf16_f32 v129, v234, v235
    v_mfma_f32_32x32x16_bf16 v[168:183], v[52:55], v[124:127], v[168:183]
    v_exp_f32 v240, v240
    v_exp_f32 v241, v241
    v_exp_f32 v242, v242
    v_exp_f32 v243, v243
    v_exp_f32 v244, v244
    v_exp_f32 v245, v245
    v_exp_f32 v246, v246
    v_exp_f32 v247, v247
    v_cvt_pk_bf16_f32 v130, v236, v237
    v_cvt_pk_bf16_f32 v131, v238, v239
    v_cvt_pk_bf16_f32 v132, v240, v241
    v_cvt_pk_bf16_f32 v133, v242, v243
    v_cvt_pk_bf16_f32 v134, v244, v245
    v_cvt_pk_bf16_f32 v135, v246, v247
    v_mfma_f32_32x32x16_bf16 v[232:247], v[56:59], v[96:99], 0
    s_add_u32 s18, s17, s29
    v_exp_f32 v216, v216
    v_exp_f32 v217, v217
    v_exp_f32 v218, v218
    v_mfma_f32_32x32x16_bf16 v[232:247], v[60:63], v[100:103], v[232:247]
    s_and_b32 s18, s18, 15
    v_exp_f32 v219, v219
    v_exp_f32 v220, v220
    v_exp_f32 v221, v221
    v_mfma_f32_32x32x16_bf16 v[184:199], v[48:51], v[128:131], v[184:199]
    s_lshl_b32 s18, s18, 12
    v_exp_f32 v222, v222
    v_exp_f32 v223, v223
    v_cvt_pk_bf16_f32 v120, v216, v217
    v_cvt_pk_bf16_f32 v121, v218, v219
    v_mfma_f32_32x32x16_bf16 v[184:199], v[52:55], v[132:135], v[184:199]
    s_add_u32 s18, s18, s16
    v_exp_f32 v224, v224
    v_exp_f32 v225, v225
    v_exp_f32 v226, v226
    v_exp_f32 v227, v227
    v_exp_f32 v228, v228
    v_exp_f32 v229, v229
    v_exp_f32 v230, v230
    v_exp_f32 v231, v231
    v_cvt_pk_bf16_f32 v122, v220, v221
    v_cvt_pk_bf16_f32 v123, v222, v223
    v_cvt_pk_bf16_f32 v124, v224, v225
    v_cvt_pk_bf16_f32 v125, v226, v227
    v_cvt_pk_bf16_f32 v126, v228, v229
    v_cvt_pk_bf16_f32 v127, v230, v231
    v_mfma_f32_32x32x16_bf16 v[216:231], v[56:59], v[104:107], 0
    v_exp_f32 v232, v232
    v_exp_f32 v233, v233
    v_exp_f32 v234, v234
    v_mfma_f32_32x32x16_bf16 v[216:231], v[60:63], v[108:111], v[216:231]
    s_add_u32 s17, s17, 1
    v_exp_f32 v235, v235
    v_exp_f32 v236, v236
    v_exp_f32 v237, v237
    v_mfma_f32_32x32x16_bf16 v[136:151], v[64:67], v[120:123], v[136:151]
    buffer_load_dwordx4 v[40:43], v2, s[8:11], s18 offen offset:0 sc1
    buffer_load_dwordx4 v[44:47], v2, s[8:11], s18 offen offset:1024 sc1
    buffer_load_dwordx4 v[48:51], v2, s[8:11], s18 offen offset:2048 sc1
    buffer_load_dwordx4 v[52:55], v2, s[8:11], s18 offen offset:3072 sc1
    v_exp_f32 v238, v238
    v_exp_f32 v239, v239
    v_cvt_pk_bf16_f32 v128, v232, v233
    v_cvt_pk_bf16_f32 v129, v234, v235
    v_mfma_f32_32x32x16_bf16 v[136:151], v[68:71], v[124:127], v[136:151]
    v_exp_f32 v240, v240
    v_exp_f32 v241, v241
    v_exp_f32 v242, v242
    v_exp_f32 v243, v243
    v_exp_f32 v244, v244
    v_exp_f32 v245, v245
    v_exp_f32 v246, v246
    v_exp_f32 v247, v247
    v_cvt_pk_bf16_f32 v130, v236, v237
    v_cvt_pk_bf16_f32 v131, v238, v239
    v_cvt_pk_bf16_f32 v132, v240, v241
    v_cvt_pk_bf16_f32 v133, v242, v243
    v_cvt_pk_bf16_f32 v134, v244, v245
    v_cvt_pk_bf16_f32 v135, v246, v247
    v_mfma_f32_32x32x16_bf16 v[232:247], v[56:59], v[200:203], 0
    v_exp_f32 v216, v216
    v_exp_f32 v217, v217
    v_exp_f32 v218, v218
    v_mfma_f32_32x32x16_bf16 v[232:247], v[60:63], v[204:207], v[232:247]
    v_exp_f32 v219, v219
    v_exp_f32 v220, v220
    v_exp_f32 v221, v221
    v_mfma_f32_32x32x16_bf16 v[152:167], v[64:67], v[128:131], v[152:167]
    v_exp_f32 v222, v222
    v_exp_f32 v223, v223
    v_cvt_pk_bf16_f32 v120, v216, v217
    v_cvt_pk_bf16_f32 v121, v218, v219
    v_mfma_f32_32x32x16_bf16 v[152:167], v[68:71], v[132:135], v[152:167]
    s_waitcnt vmcnt(8)
    v_exp_f32 v224, v224
    v_exp_f32 v225, v225
    v_exp_f32 v226, v226
    v_exp_f32 v227, v227
    v_exp_f32 v228, v228
    v_exp_f32 v229, v229
    v_exp_f32 v230, v230
    v_exp_f32 v231, v231
    v_cvt_pk_bf16_f32 v122, v220, v221
    v_cvt_pk_bf16_f32 v123, v222, v223
    v_cvt_pk_bf16_f32 v124, v224, v225
    v_cvt_pk_bf16_f32 v125, v226, v227
    v_cvt_pk_bf16_f32 v126, v228, v229
    v_cvt_pk_bf16_f32 v127, v230, v231
    v_mfma_f32_32x32x16_bf16 v[216:231], v[72:75], v[88:91], 0
    v_exp_f32 v232, v232
    v_exp_f32 v233, v233
    v_exp_f32 v234, v234
    v_mfma_f32_32x32x16_bf16 v[216:231], v[76:79], v[92:95], v[216:231]
    v_exp_f32 v235, v235
    v_exp_f32 v236, v236
    v_exp_f32 v237, v237
    v_mfma_f32_32x32x16_bf16 v[168:183], v[64:67], v[120:123], v[168:183]
    v_exp_f32 v238, v238
    v_exp_f32 v239, v239
    v_cvt_pk_bf16_f32 v128, v232, v233
    v_cvt_pk_bf16_f32 v129, v234, v235
    v_mfma_f32_32x32x16_bf16 v[168:183], v[68:71], v[124:127], v[168:183]
    v_exp_f32 v240, v240
    v_exp_f32 v241, v241
    v_exp_f32 v242, v242
    v_exp_f32 v243, v243
    v_exp_f32 v244, v244
    v_exp_f32 v245, v245
    v_exp_f32 v246, v246
    v_exp_f32 v247, v247
    v_cvt_pk_bf16_f32 v130, v236, v237
    v_cvt_pk_bf16_f32 v131, v238, v239
    v_cvt_pk_bf16_f32 v132, v240, v241
    v_cvt_pk_bf16_f32 v133, v242, v243
    v_cvt_pk_bf16_f32 v134, v244, v245
    v_cvt_pk_bf16_f32 v135, v246, v247
    v_mfma_f32_32x32x16_bf16 v[232:247], v[72:75], v[96:99], 0
    s_add_u32 s18, s17, s29
    v_exp_f32 v216, v216
    v_exp_f32 v217, v217
    v_exp_f32 v218, v218
    v_mfma_f32_32x32x16_bf16 v[232:247], v[76:79], v[100:103], v[232:247]
    s_and_b32 s18, s18, 15
    v_exp_f32 v219, v219
    v_exp_f32 v220, v220
    v_exp_f32 v221, v221
    v_mfma_f32_32x32x16_bf16 v[184:199], v[64:67], v[128:131], v[184:199]
    s_lshl_b32 s18, s18, 12
    v_exp_f32 v222, v222
    v_exp_f32 v223, v223
    v_cvt_pk_bf16_f32 v120, v216, v217
    v_cvt_pk_bf16_f32 v121, v218, v219
    v_mfma_f32_32x32x16_bf16 v[184:199], v[68:71], v[132:135], v[184:199]
    s_add_u32 s18, s18, s16
    v_exp_f32 v224, v224
    v_exp_f32 v225, v225
    v_exp_f32 v226, v226
    v_exp_f32 v227, v227
    v_exp_f32 v228, v228
    v_exp_f32 v229, v229
    v_exp_f32 v230, v230
    v_exp_f32 v231, v231
    v_cvt_pk_bf16_f32 v122, v220, v221
    v_cvt_pk_bf16_f32 v123, v222, v223
    v_cvt_pk_bf16_f32 v124, v224, v225
    v_cvt_pk_bf16_f32 v125, v226, v227
    v_cvt_pk_bf16_f32 v126, v228, v229
    v_cvt_pk_bf16_f32 v127, v230, v231
    v_mfma_f32_32x32x16_bf16 v[216:231], v[72:75], v[104:107], 0
    v_exp_f32 v232, v232
    v_exp_f32 v233, v233
    v_exp_f32 v234, v234
    v_mfma_f32_32x32x16_bf16 v[216:231], v[76:79], v[108:111], v[216:231]
    s_add_u32 s17, s17, 1
    v_exp_f32 v235, v235
    v_exp_f32 v236, v236
    v_exp_f32 v237, v237
    v_mfma_f32_32x32x16_bf16 v[136:151], v[80:83], v[120:123], v[136:151]
    buffer_load_dwordx4 v[56:59], v2, s[8:11], s18 offen offset:0 sc1
    buffer_load_dwordx4 v[60:63], v2, s[8:11], s18 offen offset:1024 sc1
    buffer_load_dwordx4 v[64:67], v2, s[8:11], s18 offen offset:2048 sc1
    buffer_load_dwordx4 v[68:71], v2, s[8:11], s18 offen offset:3072 sc1
    v_exp_f32 v238, v238
    v_exp_f32 v239, v239
    v_cvt_pk_bf16_f32 v128, v232, v233
    v_cvt_pk_bf16_f32 v129, v234, v235
    v_mfma_f32_32x32x16_bf16 v[136:151], v[84:87], v[124:127], v[136:151]
    v_exp_f32 v240, v240
    v_exp_f32 v241, v241
    v_exp_f32 v242, v242
    v_exp_f32 v243, v243
    v_exp_f32 v244, v244
    v_exp_f32 v245, v245
    v_exp_f32 v246, v246
    v_exp_f32 v247, v247
    v_cvt_pk_bf16_f32 v130, v236, v237
    v_cvt_pk_bf16_f32 v131, v238, v239
    v_cvt_pk_bf16_f32 v132, v240, v241
    v_cvt_pk_bf16_f32 v133, v242, v243
    v_cvt_pk_bf16_f32 v134, v244, v245
    v_cvt_pk_bf16_f32 v135, v246, v247
    v_mfma_f32_32x32x16_bf16 v[232:247], v[72:75], v[200:203], 0
    v_exp_f32 v216, v216
    v_exp_f32 v217, v217
    v_exp_f32 v218, v218
    v_mfma_f32_32x32x16_bf16 v[232:247], v[76:79], v[204:207], v[232:247]
    v_exp_f32 v219, v219
    v_exp_f32 v220, v220
    v_exp_f32 v221, v221
    v_mfma_f32_32x32x16_bf16 v[152:167], v[80:83], v[128:131], v[152:167]
    v_exp_f32 v222, v222
    v_exp_f32 v223, v223
    v_cvt_pk_bf16_f32 v120, v216, v217
    v_cvt_pk_bf16_f32 v121, v218, v219
    v_mfma_f32_32x32x16_bf16 v[152:167], v[84:87], v[132:135], v[152:167]
    s_waitcnt vmcnt(8)
    v_exp_f32 v224, v224
    v_exp_f32 v225, v225
    v_exp_f32 v226, v226
    v_exp_f32 v227, v227
    v_exp_f32 v228, v228
    v_exp_f32 v229, v229
    v_exp_f32 v230, v230
    v_exp_f32 v231, v231
    v_cvt_pk_bf16_f32 v122, v220, v221
    v_cvt_pk_bf16_f32 v123, v222, v223
    v_cvt_pk_bf16_f32 v124, v224, v225
    v_cvt_pk_bf16_f32 v125, v226, v227
    v_cvt_pk_bf16_f32 v126, v228, v229
    v_cvt_pk_bf16_f32 v127, v230, v231
    v_mfma_f32_32x32x16_bf16 v[216:231], v[24:27], v[88:91], 0
    v_exp_f32 v232, v232
    v_exp_f32 v233, v233
    v_exp_f32 v234, v234
    v_mfma_f32_32x32x16_bf16 v[216:231], v[28:31], v[92:95], v[216:231]
    v_exp_f32 v235, v235
    v_exp_f32 v236, v236
    v_exp_f32 v237, v237
    v_mfma_f32_32x32x16_bf16 v[168:183], v[80:83], v[120:123], v[168:183]
    v_exp_f32 v238, v238
    v_exp_f32 v239, v239
    v_cvt_pk_bf16_f32 v128, v232, v233
    v_cvt_pk_bf16_f32 v129, v234, v235
    v_mfma_f32_32x32x16_bf16 v[168:183], v[84:87], v[124:127], v[168:183]
    v_exp_f32 v240, v240
    v_exp_f32 v241, v241
    v_exp_f32 v242, v242
    v_exp_f32 v243, v243
    v_exp_f32 v244, v244
    v_exp_f32 v245, v245
    v_exp_f32 v246, v246
    v_exp_f32 v247, v247
    v_cvt_pk_bf16_f32 v130, v236, v237
    v_cvt_pk_bf16_f32 v131, v238, v239
    v_cvt_pk_bf16_f32 v132, v240, v241
    v_cvt_pk_bf16_f32 v133, v242, v243
    v_cvt_pk_bf16_f32 v134, v244, v245
    v_cvt_pk_bf16_f32 v135, v246, v247
    s_sub_u32 s20, s20, 1
    s_cmp_lg_u32 s20, 0
    s_cbranch_scc1 L_LOOP
    v_mfma_f32_32x32x16_bf16 v[232:247], v[24:27], v[96:99], 0
    s_add_u32 s18, s17, s29
    v_exp_f32 v216, v216
    v_exp_f32 v217, v217
    v_exp_f32 v218, v218
    v_mfma_f32_32x32x16_bf16 v[232:247], v[28:31], v[100:103], v[232:247]
    s_and_b32 s18, s18, 15
    v_exp_f32 v219, v219
    v_exp_f32 v220, v220
    v_exp_f32 v221, v221
    v_mfma_f32_32x32x16_bf16 v[184:199], v[80:83], v[128:131], v[184:199]
    s_lshl_b32 s18, s18, 12
    v_exp_f32 v222, v222
    v_exp_f32 v223, v223
    v_cvt_pk_bf16_f32 v120, v216, v217
    v_cvt_pk_bf16_f32 v121, v218, v219
    v_mfma_f32_32x32x16_bf16 v[184:199], v[84:87], v[132:135], v[184:199]
    s_add_u32 s18, s18, s16
    v_exp_f32 v224, v224
    v_exp_f32 v225, v225
    v_exp_f32 v226, v226
    v_exp_f32 v227, v227
    v_exp_f32 v228, v228
    v_exp_f32 v229, v229
    v_exp_f32 v230, v230
    v_exp_f32 v231, v231
    v_cvt_pk_bf16_f32 v122, v220, v221
    v_cvt_pk_bf16_f32 v123, v222, v223
    v_cvt_pk_bf16_f32 v124, v224, v225
    v_cvt_pk_bf16_f32 v125, v226, v227
    v_cvt_pk_bf16_f32 v126, v228, v229
    v_cvt_pk_bf16_f32 v127, v230, v231
    v_mfma_f32_32x32x16_bf16 v[216:231], v[24:27], v[104:107], 0
    v_exp_f32 v232, v232
    v_exp_f32 v233, v233
    v_exp_f32 v234, v234
    v_mfma_f32_32x32x16_bf16 v[216:231], v[28:31], v[108:111], v[216:231]
    s_add_u32 s17, s17, 1
    v_exp_f32 v235, v235
    v_exp_f32 v236, v236
    v_exp_f32 v237, v237
    v_mfma_f32_32x32x16_bf16 v[136:151], v[32:35], v[120:123], v[136:151]
    buffer_load_dwordx4 v[72:75], v2, s[8:11], s18 offen offset:0 sc1
    buffer_load_dwordx4 v[76:79], v2, s[8:11], s18 offen offset:1024 sc1
    buffer_load_dwordx4 v[80:83], v2, s[8:11], s18 offen offset:2048 sc1
    buffer_load_dwordx4 v[84:87], v2, s[8:11], s18 offen offset:3072 sc1
    v_exp_f32 v238, v238
    v_exp_f32 v239, v239
    v_cvt_pk_bf16_f32 v128, v232, v233
    v_cvt_pk_bf16_f32 v129, v234, v235
    v_mfma_f32_32x32x16_bf16 v[136:151], v[36:39], v[124:127], v[136:151]
    v_exp_f32 v240, v240
    v_exp_f32 v241, v241
    v_exp_f32 v242, v242
    v_exp_f32 v243, v243
    v_exp_f32 v244, v244
    v_exp_f32 v245, v245
    v_exp_f32 v246, v246
    v_exp_f32 v247, v247
    v_cvt_pk_bf16_f32 v130, v236, v237
    v_cvt_pk_bf16_f32 v131, v238, v239
    v_cvt_pk_bf16_f32 v132, v240, v241
    v_cvt_pk_bf16_f32 v133, v242, v243
    v_cvt_pk_bf16_f32 v134, v244, v245
    v_cvt_pk_bf16_f32 v135, v246, v247
    v_mfma_f32_32x32x16_bf16 v[232:247], v[24:27], v[200:203], 0
    v_exp_f32 v216, v216
    v_exp_f32 v217, v217
    v_exp_f32 v218, v218
    v_mfma_f32_32x32x16_bf16 v[232:247], v[28:31], v[204:207], v[232:247]
    v_exp_f32 v219, v219
    v_exp_f32 v220, v220
    v_exp_f32 v221, v221
    v_mfma_f32_32x32x16_bf16 v[152:167], v[32:35], v[128:131], v[152:167]
    v_exp_f32 v222, v222
    v_exp_f32 v223, v223
    v_cvt_pk_bf16_f32 v120, v216, v217
    v_cvt_pk_bf16_f32 v121, v218, v219
    v_mfma_f32_32x32x16_bf16 v[152:167], v[36:39], v[132:135], v[152:167]
    s_waitcnt vmcnt(8)
    v_exp_f32 v224, v224
    v_exp_f32 v225, v225
    v_exp_f32 v226, v226
    v_exp_f32 v227, v227
    v_exp_f32 v228, v228
    v_exp_f32 v229, v229
    v_exp_f32 v230, v230
    v_exp_f32 v231, v231
    v_cvt_pk_bf16_f32 v122, v220, v221
    v_cvt_pk_bf16_f32 v123, v222, v223
    v_cvt_pk_bf16_f32 v124, v224, v225
    v_cvt_pk_bf16_f32 v125, v226, v227
    v_cvt_pk_bf16_f32 v126, v228, v229
    v_cvt_pk_bf16_f32 v127, v230, v231
    v_mfma_f32_32x32x16_bf16 v[216:231], v[40:43], v[88:91], 0
    v_exp_f32 v232, v232
    v_exp_f32 v233, v233
    v_exp_f32 v234, v234
    v_mfma_f32_32x32x16_bf16 v[216:231], v[44:47], v[92:95], v[216:231]
    v_exp_f32 v235, v235
    v_exp_f32 v236, v236
    v_exp_f32 v237, v237
    v_mfma_f32_32x32x16_bf16 v[168:183], v[32:35], v[120:123], v[168:183]
    v_exp_f32 v238, v238
    v_exp_f32 v239, v239
    v_cvt_pk_bf16_f32 v128, v232, v233
    v_cvt_pk_bf16_f32 v129, v234, v235
    v_mfma_f32_32x32x16_bf16 v[168:183], v[36:39], v[124:127], v[168:183]
    v_exp_f32 v240, v240
    v_exp_f32 v241, v241
    v_exp_f32 v242, v242
    v_exp_f32 v243, v243
    v_exp_f32 v244, v244
    v_exp_f32 v245, v245
    v_exp_f32 v246, v246
    v_exp_f32 v247, v247
    v_cvt_pk_bf16_f32 v130, v236, v237
    v_cvt_pk_bf16_f32 v131, v238, v239
    v_cvt_pk_bf16_f32 v132, v240, v241
    v_cvt_pk_bf16_f32 v133, v242, v243
    v_cvt_pk_bf16_f32 v134, v244, v245
    v_cvt_pk_bf16_f32 v135, v246, v247
    v_mfma_f32_32x32x16_bf16 v[232:247], v[40:43], v[96:99], 0
    v_exp_f32 v216, v216
    v_exp_f32 v217, v217
    v_exp_f32 v218, v218
    v_mfma_f32_32x32x16_bf16 v[232:247], v[44:47], v[100:103], v[232:247]
    v_exp_f32 v219, v219
    v_exp_f32 v220, v220
    v_exp_f32 v221, v221
    v_mfma_f32_32x32x16_bf16 v[184:199], v[32:35], v[128:131], v[184:199]
    v_exp_f32 v222, v222
    v_exp_f32 v223, v223
    v_cvt_pk_bf16_f32 v120, v216, v217
    v_cvt_pk_bf16_f32 v121, v218, v219
    v_mfma_f32_32x32x16_bf16 v[184:199], v[36:39], v[132:135], v[184:199]
    v_exp_f32 v224, v224
    v_exp_f32 v225, v225
    v_exp_f32 v226, v226
    v_exp_f32 v227, v227
    v_exp_f32 v228, v228
    v_exp_f32 v229, v229
    v_exp_f32 v230, v230
    v_exp_f32 v231, v231
    v_cvt_pk_bf16_f32 v122, v220, v221
    v_cvt_pk_bf16_f32 v123, v222, v223
    v_cvt_pk_bf16_f32 v124, v224, v225
    v_cvt_pk_bf16_f32 v125, v226, v227
    v_cvt_pk_bf16_f32 v126, v228, v229
    v_cvt_pk_bf16_f32 v127, v230, v231
    v_mfma_f32_32x32x16_bf16 v[216:231], v[40:43], v[104:107], 0
    v_exp_f32 v232, v232
    v_exp_f32 v233, v233
    v_exp_f32 v234, v234
    v_mfma_f32_32x32x16_bf16 v[216:231], v[44:47], v[108:111], v[216:231]
    v_exp_f32 v235, v235
    v_exp_f32 v236, v236
    v_exp_f32 v237, v237
    v_mfma_f32_32x32x16_bf16 v[136:151], v[48:51], v[120:123], v[136:151]
    v_exp_f32 v238, v238
    v_exp_f32 v239, v239
    v_cvt_pk_bf16_f32 v128, v232, v233
    v_cvt_pk_bf16_f32 v129, v234, v235
    v_mfma_f32_32x32x16_bf16 v[136:151], v[52:55], v[124:127], v[136:151]
    v_exp_f32 v240, v240
    v_exp_f32 v241, v241
    v_exp_f32 v242, v242
    v_exp_f32 v243, v243
    v_exp_f32 v244, v244
    v_exp_f32 v245, v245
    v_exp_f32 v246, v246
    v_exp_f32 v247, v247
    v_cvt_pk_bf16_f32 v130, v236, v237
    v_cvt_pk_bf16_f32 v131, v238, v239
    v_cvt_pk_bf16_f32 v132, v240, v241
    v_cvt_pk_bf16_f32 v133, v242, v243
    v_cvt_pk_bf16_f32 v134, v244, v245
    v_cvt_pk_bf16_f32 v135, v246, v247
    v_mfma_f32_32x32x16_bf16 v[232:247], v[40:43], v[200:203], 0
    v_exp_f32 v216, v216
    v_exp_f32 v217, v217
    v_exp_f32 v218, v218
    v_mfma_f32_32x32x16_bf16 v[232:247], v[44:47], v[204:207], v[232:247]
    v_exp_f32 v219, v219
    v_exp_f32 v220, v220
    v_exp_f32 v221, v221
    v_mfma_f32_32x32x16_bf16 v[152:167], v[48:51], v[128:131], v[152:167]
    v_exp_f32 v222, v222
    v_exp_f32 v223, v223
    v_cvt_pk_bf16_f32 v120, v216, v217
    v_cvt_pk_bf16_f32 v121, v218, v219
    v_mfma_f32_32x32x16_bf16 v[152:167], v[52:55], v[132:135], v[152:167]
    s_waitcnt vmcnt(4)
    v_exp_f32 v224, v224
    v_exp_f32 v225, v225
    v_exp_f32 v226, v226
    v_exp_f32 v227, v227
    v_exp_f32 v228, v228
    v_exp_f32 v229, v229
    v_exp_f32 v230, v230
    v_exp_f32 v231, v231
    v_cvt_pk_bf16_f32 v122, v220, v221
    v_cvt_pk_bf16_f32 v123, v222, v223
    v_cvt_pk_bf16_f32 v124, v224, v225
    v_cvt_pk_bf16_f32 v125, v226, v227
    v_cvt_pk_bf16_f32 v126, v228, v229
    v_cvt_pk_bf16_f32 v127, v230, v231
    v_mfma_f32_32x32x16_bf16 v[216:231], v[56:59], v[88:91], 0
    v_exp_f32 v232, v232
    v_exp_f32 v233, v233
    v_exp_f32 v234, v234
    v_mfma_f32_32x32x16_bf16 v[216:231], v[60:63], v[92:95], v[216:231]
    v_exp_f32 v235, v235
    v_exp_f32 v236, v236
    v_exp_f32 v237, v237
    v_mfma_f32_32x32x16_bf16 v[168:183], v[48:51], v[120:123], v[168:183]
    v_exp_f32 v238, v238
    v_exp_f32 v239, v239
    v_cvt_pk_bf16_f32 v128, v232, v233
    v_cvt_pk_bf16_f32 v129, v234, v235
    v_mfma_f32_32x32x16_bf16 v[168:183], v[52:55], v[124:127], v[168:183]
    v_exp_f32 v240, v240
    v_exp_f32 v241, v241
    v_exp_f32 v242, v242
    v_exp_f32 v243, v243
    v_exp_f32 v244, v244
    v_exp_f32 v245, v245
    v_exp_f32 v246, v246
    v_exp_f32 v247, v247
    v_cvt_pk_bf16_f32 v130, v236, v237
    v_cvt_pk_bf16_f32 v131, v238, v239
    v_cvt_pk_bf16_f32 v132, v240, v241
    v_cvt_pk_bf16_f32 v133, v242, v243
    v_cvt_pk_bf16_f32 v134, v244, v245
    v_cvt_pk_bf16_f32 v135, v246, v247
    v_mfma_f32_32x32x16_bf16 v[232:247], v[56:59], v[96:99], 0
    v_exp_f32 v216, v216
    v_exp_f32 v217, v217
    v_exp_f32 v218, v218
    v_mfma_f32_32x32x16_bf16 v[232:247], v[60:63], v[100:103], v[232:247]
    v_exp_f32 v219, v219
    v_exp_f32 v220, v220
    v_exp_f32 v221, v221
    v_mfma_f32_32x32x16_bf16 v[184:199], v[48:51], v[128:131], v[184:199]
    v_exp_f32 v222, v222
    v_exp_f32 v223, v223
    v_cvt_pk_bf16_f32 v120, v216, v217
    v_cvt_pk_bf16_f32 v121, v218, v219
    v_mfma_f32_32x32x16_bf16 v[184:199], v[52:55], v[132:135], v[184:199]
    v_exp_f32 v224, v224
    v_exp_f32 v225, v225
    v_exp_f32 v226, v226
    v_exp_f32 v227, v227
    v_exp_f32 v228, v228
    v_exp_f32 v229, v229
    v_exp_f32 v230, v230
    v_exp_f32 v231, v231
    v_cvt_pk_bf16_f32 v122, v220, v221
    v_cvt_pk_bf16_f32 v123, v222, v223
    v_cvt_pk_bf16_f32 v124, v224, v225
    v_cvt_pk_bf16_f32 v125, v226, v227
    v_cvt_pk_bf16_f32 v126, v228, v229
    v_cvt_pk_bf16_f32 v127, v230, v231
    v_mfma_f32_32x32x16_bf16 v[216:231], v[56:59], v[104:107], 0
    v_exp_f32 v232, v232
    v_exp_f32 v233, v233
    v_exp_f32 v234, v234
    v_mfma_f32_32x32x16_bf16 v[216:231], v[60:63], v[108:111], v[216:231]
    v_exp_f32 v235, v235
    v_exp_f32 v236, v236
    v_exp_f32 v237, v237
    v_mfma_f32_32x32x16_bf16 v[136:151], v[64:67], v[120:123], v[136:151]
    v_exp_f32 v238, v238
    v_exp_f32 v239, v239
    v_cvt_pk_bf16_f32 v128, v232, v233
    v_cvt_pk_bf16_f32 v129, v234, v235
    v_mfma_f32_32x32x16_bf16 v[136:151], v[68:71], v[124:127], v[136:151]
    v_exp_f32 v240, v240
    v_exp_f32 v241, v241
    v_exp_f32 v242, v242
    v_exp_f32 v243, v243
    v_exp_f32 v244, v244
    v_exp_f32 v245, v245
    v_exp_f32 v246, v246
    v_exp_f32 v247, v247
    v_cvt_pk_bf16_f32 v130, v236, v237
    v_cvt_pk_bf16_f32 v131, v238, v239
    v_cvt_pk_bf16_f32 v132, v240, v241
    v_cvt_pk_bf16_f32 v133, v242, v243
    v_cvt_pk_bf16_f32 v134, v244, v245
    v_cvt_pk_bf16_f32 v135, v246, v247
    v_mfma_f32_32x32x16_bf16 v[232:247], v[56:59], v[200:203], 0
    v_exp_f32 v216, v216
    v_exp_f32 v217, v217
    v_exp_f32 v218, v218
    v_mfma_f32_32x32x16_bf16 v[232:247], v[60:63], v[204:207], v[232:247]
    v_exp_f32 v219, v219
    v_exp_f32 v220, v220
    v_exp_f32 v221, v221
    v_mfma_f32_32x32x16_bf16 v[152:167], v[64:67], v[128:131], v[152:167]
    v_exp_f32 v222, v222
    v_exp_f32 v223, v223
    v_cvt_pk_bf16_f32 v120, v216, v217
    v_cvt_pk_bf16_f32 v121, v218, v219
    v_mfma_f32_32x32x16_bf16 v[152:167], v[68:71], v[132:135], v[152:167]
    s_waitcnt vmcnt(0)
    v_exp_f32 v224, v224
    v_exp_f32 v225, v225
    v_exp_f32 v226, v226
    v_exp_f32 v227, v227
    v_exp_f32 v228, v228
    v_exp_f32 v229, v229
    v_exp_f32 v230, v230
    v_exp_f32 v231, v231
    v_cvt_pk_bf16_f32 v122, v220, v221
    v_cvt_pk_bf16_f32 v123, v222, v223
    v_cvt_pk_bf16_f32 v124, v224, v225
    v_cvt_pk_bf16_f32 v125, v226, v227
    v_cvt_pk_bf16_f32 v126, v228, v229
    v_cvt_pk_bf16_f32 v127, v230, v231
    v_mfma_f32_32x32x16_bf16 v[216:231], v[72:75], v[88:91], 0
    v_exp_f32 v232, v232
    v_exp_f32 v233, v233
    v_exp_f32 v234, v234
    v_mfma_f32_32x32x16_bf16 v[216:231], v[76:79], v[92:95], v[216:231]
    v_exp_f32 v235, v235
    v_exp_f32 v236, v236
    v_exp_f32 v237, v237
    v_mfma_f32_32x32x16_bf16 v[168:183], v[64:67], v[120:123], v[168:183]
    v_exp_f32 v238, v238
    v_exp_f32 v239, v239
    v_cvt_pk_bf16_f32 v128, v232, v233
    v_cvt_pk_bf16_f32 v129, v234, v235
    v_mfma_f32_32x32x16_bf16 v[168:183], v[68:71], v[124:127], v[168:183]
    v_exp_f32 v240, v240
    v_exp_f32 v241, v241
    v_exp_f32 v242, v242
    v_exp_f32 v243, v243
    v_exp_f32 v244, v244
    v_exp_f32 v245, v245
    v_exp_f32 v246, v246
    v_exp_f32 v247, v247
    v_cvt_pk_bf16_f32 v130, v236, v237
    v_cvt_pk_bf16_f32 v131, v238, v239
    v_cvt_pk_bf16_f32 v132, v240, v241
    v_cvt_pk_bf16_f32 v133, v242, v243
    v_cvt_pk_bf16_f32 v134, v244, v245
    v_cvt_pk_bf16_f32 v135, v246, v247
    v_mfma_f32_32x32x16_bf16 v[232:247], v[72:75], v[96:99], 0
    v_exp_f32 v216, v216
    v_exp_f32 v217, v217
    v_exp_f32 v218, v218
    v_mfma_f32_32x32x16_bf16 v[232:247], v[76:79], v[100:103], v[232:247]
    v_exp_f32 v219, v219
    v_exp_f32 v220, v220
    v_exp_f32 v221, v221
    v_mfma_f32_32x32x16_bf16 v[184:199], v[64:67], v[128:131], v[184:199]
    v_exp_f32 v222, v222
    v_exp_f32 v223, v223
    v_cvt_pk_bf16_f32 v120, v216, v217
    v_cvt_pk_bf16_f32 v121, v218, v219
    v_mfma_f32_32x32x16_bf16 v[184:199], v[68:71], v[132:135], v[184:199]
    v_exp_f32 v224, v224
    v_exp_f32 v225, v225
    v_exp_f32 v226, v226
    v_exp_f32 v227, v227
    v_exp_f32 v228, v228
    v_exp_f32 v229, v229
    v_exp_f32 v230, v230
    v_exp_f32 v231, v231
    v_cvt_pk_bf16_f32 v122, v220, v221
    v_cvt_pk_bf16_f32 v123, v222, v223
    v_cvt_pk_bf16_f32 v124, v224, v225
    v_cvt_pk_bf16_f32 v125, v226, v227
    v_cvt_pk_bf16_f32 v126, v228, v229
    v_cvt_pk_bf16_f32 v127, v230, v231
    v_mfma_f32_32x32x16_bf16 v[216:231], v[72:75], v[104:107], 0
    v_exp_f32 v232, v232
    v_exp_f32 v233, v233
    v_exp_f32 v234, v234
    v_mfma_f32_32x32x16_bf16 v[216:231], v[76:79], v[108:111], v[216:231]
    v_exp_f32 v235, v235
    v_exp_f32 v236, v236
    v_exp_f32 v237, v237
    v_mfma_f32_32x32x16_bf16 v[136:151], v[80:83], v[120:123], v[136:151]
    v_exp_f32 v238, v238
    v_exp_f32 v239, v239
    v_cvt_pk_bf16_f32 v128, v232, v233
    v_cvt_pk_bf16_f32 v129, v234, v235
    v_mfma_f32_32x32x16_bf16 v[136:151], v[84:87], v[124:127], v[136:151]
    v_exp_f32 v240, v240
    v_exp_f32 v241, v241
    v_exp_f32 v242, v242
    v_exp_f32 v243, v243
    v_exp_f32 v244, v244
    v_exp_f32 v245, v245
    v_exp_f32 v246, v246
    v_exp_f32 v247, v247
    v_cvt_pk_bf16_f32 v130, v236, v237
    v_cvt_pk_bf16_f32 v131, v238, v239
    v_cvt_pk_bf16_f32 v132, v240, v241
    v_cvt_pk_bf16_f32 v133, v242, v243
    v_cvt_pk_bf16_f32 v134, v244, v245
    v_cvt_pk_bf16_f32 v135, v246, v247
    v_mfma_f32_32x32x16_bf16 v[232:247], v[72:75], v[200:203], 0
    ds_write_b128 v16, v[136:139] offset:0
    v_exp_f32 v216, v216
    v_exp_f32 v217, v217
    v_exp_f32 v218, v218
    v_mfma_f32_32x32x16_bf16 v[232:247], v[76:79], v[204:207], v[232:247]
    ds_write_b128 v16, v[140:143] offset:1024
    v_exp_f32 v219, v219
    v_exp_f32 v220, v220
    v_exp_f32 v221, v221
    v_mfma_f32_32x32x16_bf16 v[152:167], v[80:83], v[128:131], v[152:167]
    ds_write_b128 v16, v[144:147] offset:2048
    v_exp_f32 v222, v222
    v_exp_f32 v223, v223
    v_cvt_pk_bf16_f32 v120, v216, v217
    v_cvt_pk_bf16_f32 v121, v218, v219
    v_mfma_f32_32x32x16_bf16 v[152:167], v[84:87], v[132:135], v[152:167]
    ds_write_b128 v16, v[148:151] offset:3072
    v_exp_f32 v224, v224
    v_exp_f32 v225, v225
    v_exp_f32 v226, v226
    v_exp_f32 v227, v227
    v_exp_f32 v228, v228
    v_exp_f32 v229, v229
    v_exp_f32 v230, v230
    v_exp_f32 v231, v231
    v_cvt_pk_bf16_f32 v122, v220, v221
    v_cvt_pk_bf16_f32 v123, v222, v223
    v_cvt_pk_bf16_f32 v124, v224, v225
    v_cvt_pk_bf16_f32 v125, v226, v227
    v_cvt_pk_bf16_f32 v126, v228, v229
    v_cvt_pk_bf16_f32 v127, v230, v231
    ds_write_b128 v17, v[152:155] offset:4096
    v_exp_f32 v232, v232
    v_exp_f32 v233, v233
    v_exp_f32 v234, v234
    ds_write_b128 v17, v[156:159] offset:5120
    v_exp_f32 v235, v235
    v_exp_f32 v236, v236
    v_exp_f32 v237, v237
    v_mfma_f32_32x32x16_bf16 v[168:183], v[80:83], v[120:123], v[168:183]
    ds_write_b128 v17, v[160:163] offset:6144
    v_exp_f32 v238, v238
    v_exp_f32 v239, v239
    v_cvt_pk_bf16_f32 v128, v232, v233
    v_cvt_pk_bf16_f32 v129, v234, v235
    v_mfma_f32_32x32x16_bf16 v[168:183], v[84:87], v[124:127], v[168:183]
    ds_write_b128 v17, v[164:167] offset:7168
    v_exp_f32 v240, v240
    v_exp_f32 v241, v241
    v_exp_f32 v242, v242
    v_exp_f32 v243, v243
    v_exp_f32 v244, v244
    v_exp_f32 v245, v245
    v_exp_f32 v246, v246
    v_exp_f32 v247, v247
    v_cvt_pk_bf16_f32 v130, v236, v237
    v_cvt_pk_bf16_f32 v131, v238, v239
    v_cvt_pk_bf16_f32 v132, v240, v241
    v_cvt_pk_bf16_f32 v133, v242, v243
    v_cvt_pk_bf16_f32 v134, v244, v245
    v_cvt_pk_bf16_f32 v135, v246, v247
    v_mfma_f32_32x32x16_bf16 v[184:199], v[80:83], v[128:131], v[184:199]
    ds_write_b128 v18, v[168:171] offset:8192
    ds_write_b128 v18, v[172:175] offset:9216
    v_mfma_f32_32x32x16_bf16 v[184:199], v[84:87], v[132:135], v[184:199]
    ds_write_b128 v18, v[176:179] offset:10240
    ds_write_b128 v18, v[180:183] offset:11264
    v_mov_b32 v12, 153600
    v_mov_b32 v13, 1
    s_add_u32 s21, s21, 4
    s_mov_b64 exec, 1
    ds_add_u32 v12, v13
    s_mov_b64 exec, -1
    s_mov_b32 s56, 131072
L_AS2:
    ds_read_b32 v13, v12
    s_sub_u32 s56, s56, 1
    s_cbranch_scc1 L_ASX2
    s_waitcnt lgkmcnt(0)
    v_readfirstlane_b32 s32, v13
    s_cmp_lt_u32 s32, s21
    s_cbranch_scc1 L_AS2
L_ASX2:
    ds_read_b128 v[136:139], v19 offset:0
    ds_read_b128 v[140:143], v19 offset:1024
    ds_read_b128 v[144:147], v19 offset:2048
    ds_read_b128 v[148:151], v19 offset:3072
    ds_read_b128 v[152:155], v19 offset:4096
    ds_read_b128 v[156:159], v19 offset:5120
    ds_read_b128 v[160:163], v19 offset:6144
    ds_read_b128 v[164:167], v19 offset:7168
    ds_read_b128 v[168:171], v19 offset:8192
    ds_read_b128 v[172:175], v19 offset:9216
    ds_read_b128 v[176:179], v19 offset:10240
    ds_read_b128 v[180:183], v19 offset:11264
    s_lshr_b32 s33, s5, 1
    s_mul_i32 s33, s33, 72
    s_add_u32 s33, s33, s30
    s_add_u32 s33, s33, 56
    s_lshl_b32 s33, s33, 2
    s_and_b32 s32, s5, 1
    s_add_u32 s33, s33, s32
    s_lshl_b32 s33, s33, 10
    s_add_u32 s33, s33, 0x600000
    s_waitcnt lgkmcnt(8)
    v_add_f32 v136, v136, v184
    v_add_f32 v137, v137, v185
    v_add_f32 v138, v138, v186
    v_add_f32 v139, v139, v187
    v_add_f32 v140, v140, v188
    v_add_f32 v141, v141, v189
    v_add_f32 v142, v142, v190
    v_add_f32 v143, v143, v191
    v_add_f32 v144, v144, v192
    v_add_f32 v145, v145, v193
    v_add_f32 v146, v146, v194
    v_add_f32 v147, v147, v195
    v_add_f32 v148, v148, v196
    v_add_f32 v149, v149, v197
    v_add_f32 v150, v150, v198
    v_add_f32 v151, v151, v199
    s_waitcnt lgkmcnt(0)
    v_add_f32 v152, v152, v168
    v_add_f32 v153, v153, v169
    v_add_f32 v154, v154, v170
    v_add_f32 v155, v155, v171
    v_add_f32 v156, v156, v172
    v_add_f32 v157, v157, v173
    v_add_f32 v158, v158, v174
    v_add_f32 v159, v159, v175
    v_add_f32 v160, v160, v176
    v_add_f32 v161, v161, v177
    v_add_f32 v162, v162, v178
    v_add_f32 v163, v163, v179
    v_add_f32 v164, v164, v180
    v_add_f32 v165, v165, v181
    v_add_f32 v166, v166, v182
    v_add_f32 v167, v167, v183
    v_add_f32 v143, v143, v159
    v_add_f32 v136, v136, v152
    v_rcp_f32 v18, v143
    v_add_f32 v137, v137, v153
    v_add_f32 v138, v138, v154
    v_add_f32 v139, v139, v155
    v_add_f32 v140, v140, v156
    v_add_f32 v141, v141, v157
    v_add_f32 v142, v142, v158
    v_add_f32 v144, v144, v160
    v_add_f32 v145, v145, v161
    v_add_f32 v146, v146, v162
    v_add_f32 v147, v147, v163
    v_add_f32 v148, v148, v164
    v_add_f32 v149, v149, v165
    v_add_f32 v150, v150, v166
    v_add_f32 v151, v151, v167
    v_maximum3_f32 v19, abs(v136), abs(v137), abs(v138)
    v_maximum3_f32 v19, abs(v139), abs(v140), v19
    v_maximum3_f32 v19, abs(v141), abs(v142), v19
    v_maximum3_f32 v19, abs(v144), abs(v145), v19
    v_maximum3_f32 v19, abs(v146), abs(v147), v19
    v_maximum3_f32 v19, abs(v148), abs(v149), v19
    v_maximum3_f32 v19, abs(v150), abs(v150), v19
    v_mov_b32 v20, 0x7e800000
    v_cmp_gt_f32 vcc, 0xa800000, v19
    v_maximum3_f32 v19, v143, v143, v19
    v_cmp_nlt_f32 s[64:65], v19, v20
    s_or_b64 s[64:65], s[64:65], vcc
    v_mul_f32 v136, v136, v18
    v_mul_f32 v137, v137, v18
    v_mul_f32 v138, v138, v18
    v_mul_f32 v139, v139, v18
    v_mul_f32 v140, v140, v18
    v_mul_f32 v141, v141, v18
    v_mul_f32 v142, v142, v18
    v_mul_f32 v143, v143, v18
    v_mul_f32 v144, v144, v18
    v_mul_f32 v145, v145, v18
    v_mul_f32 v146, v146, v18
    v_mul_f32 v147, v147, v18
    v_mul_f32 v148, v148, v18
    v_mul_f32 v149, v149, v18
    v_mul_f32 v150, v150, v18
    v_mul_f32 v151, v151, v18
    v_cvt_pk_bf16_f32 v120, v136, v137
    v_cvt_pk_bf16_f32 v121, v138, v139
    v_cvt_pk_bf16_f32 v122, v140, v141
    v_cvt_pk_bf16_f32 v123, v142, v143
    v_cvt_pk_bf16_f32 v124, v144, v145
    v_cvt_pk_bf16_f32 v125, v146, v147
    v_cvt_pk_bf16_f32 v126, v148, v149
    v_cvt_pk_bf16_f32 v127, v150, v151
    s_or_b32 s64, s64, s65
    s_cmp_lg_u32 s19, 0
    s_cselect_b32 s64, 0, s64
    s_cmp_lg_u32 s64, 0
    s_cbranch_scc1 L_NOPUB
    s_cmp_eq_u32 s19, 2
    s_cbranch_scc1 L_NOPUB
    buffer_store_dwordx4 v[120:123], v2, s[8:11], s33 offen offset:0 sc1
    buffer_store_dwordx4 v[124:127], v2, s[8:11], s33 offen offset:2048 sc1
L_NOPUB:
    s_cmp_lg_u32 s19, 0
    s_cbranch_scc1 L_AEND
    v_mov_b32 v16, 153604
    v_mov_b32 v17, s64
    ds_or_b32 v16, v17
    v_mov_b32 v12, 153600
    v_mov_b32 v13, 1
    s_add_u32 s21, s21, 4
    s_mov_b64 exec, 1
    ds_add_u32 v12, v13
    s_mov_b64 exec, -1
    s_mov_b32 s56, 131072
L_AS3:
    ds_read_b32 v13, v12
    s_sub_u32 s56, s56, 1
    s_cbranch_scc1 L_ASX3
    s_waitcnt lgkmcnt(0)
    v_readfirstlane_b32 s32, v13
    s_cmp_lt_u32 s32, s21
    s_cbranch_scc1 L_AS3
L_ASX3:
    ds_read_b32 v17, v16
    s_waitcnt lgkmcnt(0)
    v_readfirstlane_b32 s32, v17
    s_cmp_eq_u32 s32, 0
    s_cbranch_scc1 L_AEND
    s_cmp_lg_u32 s64, 0
    s_cselect_b32 s19, 1, 2
    s_branch L_RESTART
L_AEND:
    s_endpgm
L_SP0:
    s_mov_b32 s56, 1048576
L_SPL0:
    ds_read_b32 v253, v255 offset:48
    s_sub_u32 s56, s56, 1
    s_cbranch_scc1 L_SPB0
    s_waitcnt lgkmcnt(0)
    v_cmp_gt_u32 vcc, 1, v253
    s_cbranch_vccnz L_SPL0
    s_branch L_SPB0
L_SP1:
    s_mov_b32 s56, 1048576
L_SPL1:
    ds_read_b32 v253, v255 offset:64
    s_sub_u32 s56, s56, 1
    s_cbranch_scc1 L_SPB1
    s_waitcnt lgkmcnt(0)
    v_cmp_gt_u32 vcc, 12, v253
    s_cbranch_vccnz L_SPL1
    s_branch L_SPB1
L_SP2:
    s_mov_b32 s56, 1048576
L_SPL2:
    ds_read_b32 v253, v255 offset:64
    s_sub_u32 s56, s56, 1
    s_cbranch_scc1 L_SPB2
    s_waitcnt lgkmcnt(0)
    v_cmp_gt_u32 vcc, 14, v253
    s_cbranch_vccnz L_SPL2
    s_branch L_SPB2
L_SP3:
    s_mov_b32 s56, 1048576
L_SPL3:
    ds_read_b32 v253, v255 offset:80
    s_sub_u32 s56, s56, 1
    s_cbranch_scc1 L_SPB3
    s_waitcnt lgkmcnt(0)
    v_cmp_gt_u32 vcc, 11, v253
    s_cbranch_vccnz L_SPL3
    s_branch L_SPB3
L_SP4:
    s_mov_b32 s56, 1048576
L_SPL4:
    ds_read_b32 v253, v255 offset:48
    s_sub_u32 s56, s56, 1
    s_cbranch_scc1 L_SPB4
    s_waitcnt lgkmcnt(0)
    v_cmp_gt_u32 vcc, 2, v253
    s_cbranch_vccnz L_SPL4
    s_branch L_SPB4
L_RESTART:
    s_mov_b32 s17, 0
    s_add_u32 s18, s17, s29
    s_and_b32 s18, s18, 15
    s_lshl_b32 s18, s18, 12
    s_add_u32 s18, s18, s16
    buffer_load_dwordx4 v[24:27], v2, s[8:11], s18 offen offset:0 sc1
    buffer_load_dwordx4 v[28:31], v2, s[8:11], s18 offen offset:1024 sc1
    buffer_load_dwordx4 v[32:35], v2, s[8:11], s18 offen offset:2048 sc1
    buffer_load_dwordx4 v[36:39], v2, s[8:11], s18 offen offset:3072 sc1
    s_add_u32 s17, s17, 1
    s_add_u32 s18, s17, s29
    s_and_b32 s18, s18, 15
    s_lshl_b32 s18, s18, 12
    s_add_u32 s18, s18, s16
    buffer_load_dwordx4 v[40:43], v2, s[8:11], s18 offen offset:0 sc1
    buffer_load_dwordx4 v[44:47], v2, s[8:11], s18 offen offset:1024 sc1
    buffer_load_dwordx4 v[48:51], v2, s[8:11], s18 offen offset:2048 sc1
    buffer_load_dwordx4 v[52:55], v2, s[8:11], s18 offen offset:3072 sc1
    s_add_u32 s17, s17, 1
    s_add_u32 s18, s17, s29
    s_and_b32 s18, s18, 15
    s_lshl_b32 s18, s18, 12
    s_add_u32 s18, s18, s16
    buffer_load_dwordx4 v[56:59], v2, s[8:11], s18 offen offset:0 sc1
    buffer_load_dwordx4 v[60:63], v2, s[8:11], s18 offen offset:1024 sc1
    buffer_load_dwordx4 v[64:67], v2, s[8:11], s18 offen offset:2048 sc1
    buffer_load_dwordx4 v[68:71], v2, s[8:11], s18 offen offset:3072 sc1
    s_add_u32 s17, s17, 1
    v_mov_b32 v208, 0xff800000
    v_cndmask_b32 v94, v94, 0, s[36:37]
    v_cndmask_b32 v95, v95, 0, s[36:37]
    v_mov_b32 v209, 0xff800000
    v_cndmask_b32 v102, v102, 0, s[36:37]
    v_cndmask_b32 v103, v103, 0, s[36:37]
    v_mov_b32 v210, 0xff800000
    v_cndmask_b32 v110, v110, 0, s[36:37]
    v_cndmask_b32 v111, v111, 0, s[36:37]
    v_mov_b32 v211, 0xff800000
    v_cndmask_b32 v206, v206, 0, s[36:37]
    v_cndmask_b32 v207, v207, 0, s[36:37]
    s_mov_b32 s17, 0
L_MAXLOOP:
    s_add_u32 s18, s17, s29
    s_and_b32 s18, s18, 15
    s_lshl_b32 s18, s18, 12
    s_add_u32 s18, s18, s16
    buffer_load_dwordx4 v[72:75], v2, s[8:11], s18 offen offset:0 sc1
    buffer_load_dwordx4 v[76:79], v2, s[8:11], s18 offen offset:1024 sc1
    s_add_u32 s17, s17, 1
    s_waitcnt vmcnt(0)
    v_mfma_f32_32x32x16_bf16 v[136:151], v[72:75], v[88:91], 0
    v_mfma_f32_32x32x16_bf16 v[136:151], v[76:79], v[92:95], v[136:151]
    v_mfma_f32_32x32x16_bf16 v[152:167], v[72:75], v[96:99], 0
    v_mfma_f32_32x32x16_bf16 v[152:167], v[76:79], v[100:103], v[152:167]
    v_mfma_f32_32x32x16_bf16 v[168:183], v[72:75], v[104:107], 0
    v_mfma_f32_32x32x16_bf16 v[168:183], v[76:79], v[108:111], v[168:183]
    v_mfma_f32_32x32x16_bf16 v[184:199], v[72:75], v[200:203], 0
    v_mfma_f32_32x32x16_bf16 v[184:199], v[76:79], v[204:207], v[184:199]
    s_nop 5
    v_max3_f32 v208, v136, v137, v208
    v_max3_f32 v208, v138, v139, v208
    v_max3_f32 v208, v140, v141, v208
    v_max3_f32 v208, v142, v143, v208
    v_max3_f32 v208, v144, v145, v208
    v_max3_f32 v208, v146, v147, v208
    v_max3_f32 v208, v148, v149, v208
    v_max3_f32 v208, v150, v151, v208
    v_max3_f32 v209, v152, v153, v209
    v_max3_f32 v209, v154, v155, v209
    v_max3_f32 v209, v156, v157, v209
    v_max3_f32 v209, v158, v159, v209
    v_max3_f32 v209, v160, v161, v209
    v_max3_f32 v209, v162, v163, v209
    v_max3_f32 v209, v164, v165, v209
    v_max3_f32 v209, v166, v167, v209
    v_max3_f32 v210, v168, v169, v210
    v_max3_f32 v210, v170, v171, v210
    v_max3_f32 v210, v172, v173, v210
    v_max3_f32 v210, v174, v175, v210
    v_max3_f32 v210, v176, v177, v210
    v_max3_f32 v210, v178, v179, v210
    v_max3_f32 v210, v180, v181, v210
    v_max3_f32 v210, v182, v183, v210
    v_max3_f32 v211, v184, v185, v211
    v_max3_f32 v211, v186, v187, v211
    v_max3_f32 v211, v188, v189, v211
    v_max3_f32 v211, v190, v191, v211
    v_max3_f32 v211, v192, v193, v211
    v_max3_f32 v211, v194, v195, v211
    v_max3_f32 v211, v196, v197, v211
    v_max3_f32 v211, v198, v199, v211
    s_cmp_lt_u32 s17, 16
    s_cbranch_scc1 L_MAXLOOP
    s_mov_b32 s17, 3
    v_mov_b32 v16, v208
    v_mov_b32 v17, v209
    v_mov_b32 v18, v210
    v_mov_b32 v19, v211
    v_permlane32_swap_b32 v208, v16
    v_permlane32_swap_b32 v209, v17
    v_permlane32_swap_b32 v210, v18
    v_permlane32_swap_b32 v211, v19
    v_max_f32 v208, v208, v16
    v_max_f32 v209, v209, v17
    v_max_f32 v210, v210, v18
    v_max_f32 v211, v211, v19
    v_lshlrev_b32 v20, 2, v1
    s_add_u32 s33, s28, 1
    s_and_b32 s33, s33, 3
    s_lshl_b32 s33, s33, 10
    s_add_u32 s33, s33, 155648
    v_add_u32 v16, s33, v20
    s_add_u32 s33, s28, 2
    s_and_b32 s33, s33, 3
    s_lshl_b32 s33, s33, 10
    s_add_u32 s33, s33, 155648
    v_add_u32 v17, s33, v20
    s_add_u32 s33, s28, 3
    s_and_b32 s33, s33, 3
    s_lshl_b32 s33, s33, 10
    s_add_u32 s33, s33, 155648
    v_add_u32 v18, s33, v20
    s_add_u32 s33, s28, 4
    s_and_b32 s33, s33, 3
    s_lshl_b32 s33, s33, 10
    s_add_u32 s33, s33, 155648
    v_add_u32 v19, s33, v20
    s_lshl_b32 s32, s28, 8
    v_add_u32 v21, s32, v16
    ds_write_b32 v21, v208
    v_add_u32 v21, s32, v17
    ds_write_b32 v21, v209
    v_add_u32 v21, s32, v18
    ds_write_b32 v21, v210
    v_add_u32 v21, s32, v19
    ds_write_b32 v21, v211
    v_mov_b32 v12, 153600
    v_mov_b32 v13, 1
    s_add_u32 s21, s21, 4
    s_mov_b64 exec, 1
    ds_add_u32 v12, v13
    s_mov_b64 exec, -1
    s_mov_b32 s56, 131072
L_AS1:
    ds_read_b32 v13, v12
    s_sub_u32 s56, s56, 1
    s_cbranch_scc1 L_ASX1
    s_waitcnt lgkmcnt(0)
    v_readfirstlane_b32 s32, v13
    s_cmp_lt_u32 s32, s21
    s_cbranch_scc1 L_AS1
L_ASX1:
    ds_read2_b32 v[216:217], v16 offset0:0 offset1:64
    ds_read2_b32 v[218:219], v16 offset0:128 offset1:192
    ds_read2_b32 v[220:221], v17 offset0:0 offset1:64
    ds_read2_b32 v[222:223], v17 offset0:128 offset1:192
    ds_read2_b32 v[224:225], v18 offset0:0 offset1:64
    ds_read2_b32 v[226:227], v18 offset0:128 offset1:192
    ds_read2_b32 v[228:229], v19 offset0:0 offset1:64
    ds_read2_b32 v[230:231], v19 offset0:128 offset1:192
    s_waitcnt lgkmcnt(0)
    v_max3_f32 v208, v216, v217, v218
    v_max_f32 v208, v208, v219
    v_max3_f32 v209, v220, v221, v222
    v_max_f32 v209, v209, v223
    v_max3_f32 v210, v224, v225, v226
    v_max_f32 v210, v210, v227
    v_max3_f32 v211, v228, v229, v230
    v_max_f32 v211, v211, v231
    v_sub_f32 v208, 0, v208
    v_and_b32 v16, s35, v208
    v_sub_f32 v208, v208, v16
    v_and_b32 v17, s35, v208
    v_sub_f32 v208, v208, v17
    v_lshrrev_b32 v16, 16, v16
    v_or_b32 v16, v16, v17
    v_lshrrev_b32 v18, 16, v208
    v_cndmask_b32 v94, v94, v16, s[36:37]
    v_cndmask_b32 v95, v95, v18, s[36:37]
    v_sub_f32 v209, 0, v209
    v_and_b32 v16, s35, v209
    v_sub_f32 v209, v209, v16
    v_and_b32 v17, s35, v209
    v_sub_f32 v209, v209, v17
    v_lshrrev_b32 v16, 16, v16
    v_or_b32 v16, v16, v17
    v_lshrrev_b32 v18, 16, v209
    v_cndmask_b32 v102, v102, v16, s[36:37]
    v_cndmask_b32 v103, v103, v18, s[36:37]
    v_sub_f32 v210, 0, v210
    v_and_b32 v16, s35, v210
    v_sub_f32 v210, v210, v16
    v_and_b32 v17, s35, v210
    v_sub_f32 v210, v210, v17
    v_lshrrev_b32 v16, 16, v16
    v_or_b32 v16, v16, v17
    v_lshrrev_b32 v18, 16, v210
    v_cndmask_b32 v110, v110, v16, s[36:37]
    v_cndmask_b32 v111, v111, v18, s[36:37]
    v_sub_f32 v211, 0, v211
    v_and_b32 v16, s35, v211
    v_sub_f32 v211, v211, v16
    v_and_b32 v17, s35, v211
    v_sub_f32 v211, v211, v17
    v_lshrrev_b32 v16, 16, v16
    v_or_b32 v16, v16, v17
    v_lshrrev_b32 v18, 16, v211
    v_cndmask_b32 v206, v206, v16, s[36:37]
    v_cndmask_b32 v207, v207, v18, s[36:37]
    s_branch L_GO
L_END:
    s_endpgm
.section .rodata,"a"
.p2align 6
.amdhsa_kernel parallel_sum__softmax_full_mha__dense_activation_relu__prompt_kernel
  .amdhsa_next_free_vgpr 256
  .amdhsa_next_free_sgpr 102
  .amdhsa_accum_offset 256
  .amdhsa_group_segment_fixed_size 0
  .amdhsa_kernarg_size 72
  .amdhsa_user_sgpr_count 2
  .amdhsa_user_sgpr_kernarg_segment_ptr 1
  .amdhsa_system_sgpr_workgroup_id_x 1
.end_amdhsa_kernel
```
